```python
import torch

def _softmax(x, axis=-1):
    return torch.softmax(x, dim=axis)
def _gelu(x):
    return torch.nn.functional.gelu(x, approximate="tanh")
def _silu(x):
    return torch.nn.functional.silu(x)
def _sigmoid(x):
    return torch.sigmoid(x)
def _layernorm(x, axis=-1, eps=1e-5):
    m = x.mean(dim=axis, keepdim=True)
    v = x.var(dim=axis, keepdim=True, unbiased=False)
    return (x - m) / torch.sqrt(v + eps)
def _scatter_add(tgt, idx, src, axis=0):
    return tgt.clone().index_add_(axis, idx, src)
def _segment_sum(src, seg, n):
    out = torch.zeros((n,) + src.shape[1:], dtype=src.dtype)
    return out.index_add_(0, seg, src)
def _pad(x, pw):
    flat = tuple(v for pair in reversed(pw) for v in pair)
    return torch.nn.functional.pad(x, flat)

kernel_name = 'recurrent_scan__gqa_block_cached__swiglu_ffn__decode'

def setup_inputs():

    _w = (lambda a: (lambda t: t.to(torch.bfloat16) if t.is_floating_point() else t)(torch.as_tensor(a)))
    def _A_setup():
        B, Sq, D = 1, 1, 1024
        Hq, Hkv, Sk, Dh = 32, 4, 65536, 128
        assert Hq % Hkv == 0, (Hq, Hkv)
        return {
            "x": _w((lambda *s: torch.randn(*s, dtype=torch.bfloat16) * 0.05)(B, Sq, D)),
            "k_cache": _w((lambda *s: torch.randn(*s, dtype=torch.bfloat16) * 1.6)(B, Hkv, Sk, Dh)),
            "v_cache": _w((lambda *s: torch.randn(*s, dtype=torch.bfloat16) * 0.2)(B, Hkv, Sk, Dh)),
            "wq": _w((lambda *s: torch.randn(*s, dtype=torch.bfloat16) * 1.6)(D, Hq * Dh) * (D ** -0.5)),
            "wo": _w((lambda *s: torch.randn(*s, dtype=torch.bfloat16) * 0.2)(Hq * Dh, D) * ((Hq * Dh) ** -0.5)),
        }
    _A_in = _A_setup()

    def _B_setup():
        B, S, D, F = 1, 1, 1024, 3584
        return {
            "x": _w((lambda *s: torch.randn(*s, dtype=torch.bfloat16) * 0.05)(B, S, D)),
            "w_gate": _w((lambda *s: torch.randn(*s, dtype=torch.bfloat16) * 0.1)(D, F)),
            "w_up": _w((lambda *s: torch.randn(*s, dtype=torch.bfloat16) * 0.1)(D, F)),
            "w_down": _w((lambda *s: torch.randn(*s, dtype=torch.bfloat16) * 0.1)(F, D)),
        }
    _B_in = _B_setup()

    return {
        "A_x": _A_in["x"],
        "A_k_cache": _A_in["k_cache"],
        "A_v_cache": _A_in["v_cache"],
        "A_wq": _A_in["wq"],
        "A_wo": _A_in["wo"],
        "B_x": _B_in["x"],
        "B_w_gate": _B_in["w_gate"],
        "B_w_up": _B_in["w_up"],
        "B_w_down": _B_in["w_down"],
    }

def reference(A_x, A_k_cache, A_v_cache, A_wq, A_wo, B_x, B_w_gate, B_w_up, B_w_down):
    def _A_ref(x, k_cache, v_cache, wq, wo):
        B, Sq, D = x.shape
        Hq, Dh = 32, 128
        Hkv = k_cache.shape[1]
        rep = Hq // Hkv
        q = (lambda x, *d: x.permute(*d))((x @ wq).reshape(B, Sq, Hq, Dh), 0, 2, 1, 3)
        k = (lambda x, n, axis: torch.repeat_interleave(x, n, dim=axis))(k_cache, rep, axis=1)
        v = (lambda x, n, axis: torch.repeat_interleave(x, n, dim=axis))(v_cache, rep, axis=1)
        scores = torch.einsum("bhqd,bhkd->bhqk", q, k) * (Dh ** -0.5)
        p = _softmax(scores, axis=-1)
        o = torch.einsum("bhqk,bhkd->bhqd", p, v)
        return (lambda x, *d: x.permute(*d))(o, 0, 2, 1, 3).reshape(B, Sq, Hq * Dh) @ wo

    def _B_ref(x, w_gate, w_up, w_down):
        g = _silu(x @ w_gate)
        u = x @ w_up
        return (g * u) @ w_down

    x = A_x
    xn = _layernorm(x, axis=-1)
    s = _A_ref(xn, A_k_cache, A_v_cache, A_wq, A_wo)
    g = _silu(_B_ref(xn, B_w_gate, B_w_up, B_w_down))
    return x + s * g
```

```asm
; @launch grid=(256,1,1) block=(576,1,1) lds=159744
.amdgcn_target "amdgcn-amd-amdhsa--gfx950"
.text
.globl recurrent_scan__gqa_block_cached__swiglu_ffn__decode_kernel
.p2align 8
.type recurrent_scan__gqa_block_cached__swiglu_ffn__decode_kernel,@function
recurrent_scan__gqa_block_cached__swiglu_ffn__decode_kernel:
    s_cmp_ge_u32 s2, 256
    s_cbranch_scc1 L_end
    s_load_dwordx16 s[4:19], s[0:1], 0
    s_load_dwordx8 s[20:27], s[0:1], 64
    v_lshlrev_b32 v2, 2, v0
    v_add_u32 v2, 131072, v2
    v_mov_b32 v3, 0
    ds_write_b32 v2, v3
    v_lshrrev_b32 v1, 6, v0
    v_and_b32 v0, 63, v0
    v_readfirstlane_b32 s3, v1
    s_mov_b32 s60, 8388608
    s_lshr_b32 s64, s2, 6
    s_and_b32 s65, s2, 63
    s_lshr_b32 s68, s65, 3
    s_and_b32 s72, s2, 1
    s_lshl_b32 s73, s72, 3
    s_or_b32 s68, s68, s73
    s_bfe_u32 s69, s2, 0x20001
    s_lshr_b32 s71, s2, 7
    s_lshl_b32 s71, s71, 2
    s_or_b32 s71, s71, s69
    s_and_b32 s76, s3, 3
    s_lshl_b32 s40, s69, 2
    s_add_u32 s40, s40, s76
    v_lshlrev_b32 v107, 4, v0
    v_and_b32 v106, 0x300, v107
    v_lshrrev_b32 v106, 4, v106
    s_waitcnt lgkmcnt(0)
    s_cmp_lt_u32 s3, 4
    s_cbranch_scc1 L_L
    s_load_dword s79, s[26:27], 0x68000
    s_mov_b32 s32, s4
    s_mov_b32 s33, s5
    s_mov_b32 s34, 2048
    s_mov_b32 s35, 0x20000
    s_cmp_eq_u32 s3, 8
    s_cbranch_scc1 L_P
    s_lshl_b32 s41, s71, 2
    s_add_u32 s41, s41, s76
    s_lshl_b32 s41, s41, 6
    s_lshl_b32 s40, s40, 7
    buffer_load_dwordx4 v[64:67], v107, s[32:35], 0 offen
    buffer_load_dwordx4 v[68:71], v107, s[32:35], 0 offen offset:1024
    buffer_load_dwordx4 v[128:131], v106, s[32:35], s40 offen
    buffer_load_dwordx4 v[132:135], v106, s[32:35], s40 offen offset:64
    buffer_load_dwordx4 v[136:139], v106, s[32:35], s41 offen
    s_barrier
    s_branch L_C
L_L:
    s_setprio 3
    v_lshrrev_b32 v2, 3, v0
    v_lshlrev_b32 v2, 13, v2
    v_and_b32 v3, 7, v0
    v_lshl_or_b32 v2, v3, 4, v2
    s_lshl_b32 s52, s40, 19
    s_lshl_b32 s73, s64, 11
    s_add_u32 s52, s52, s73
    s_lshl_b32 s73, s68, 7
    s_add_u32 s52, s52, s73
    s_lshl_b32 s57, s3, 15
    s_mov_b32 s28, s10
    s_mov_b32 s29, s11
    s_mov_b32 s30, 8388608
    s_mov_b32 s31, 0x20000
    s_add_u32 m0, s57, 0
    s_nop 0
    buffer_load_dwordx4 v2, s[28:31], s52 offen nt lds
    s_add_u32 s52, s52, 65536
    s_add_u32 m0, s57, 1024
    s_nop 0
    buffer_load_dwordx4 v2, s[28:31], s52 offen nt lds
    s_add_u32 s52, s52, 65536
    s_add_u32 m0, s57, 2048
    s_nop 0
    buffer_load_dwordx4 v2, s[28:31], s52 offen nt lds
    s_add_u32 s52, s52, 65536
    s_add_u32 m0, s57, 3072
    s_nop 0
    buffer_load_dwordx4 v2, s[28:31], s52 offen nt lds
    s_add_u32 s52, s52, 65536
    s_add_u32 m0, s57, 4096
    s_nop 0
    buffer_load_dwordx4 v2, s[28:31], s52 offen nt lds
    s_add_u32 s52, s52, 65536
    s_add_u32 m0, s57, 5120
    s_nop 0
    buffer_load_dwordx4 v2, s[28:31], s52 offen nt lds
    s_add_u32 s52, s52, 65536
    s_add_u32 m0, s57, 6144
    s_nop 0
    buffer_load_dwordx4 v2, s[28:31], s52 offen nt lds
    s_add_u32 s52, s52, 65536
    s_add_u32 m0, s57, 7168
    s_nop 0
    buffer_load_dwordx4 v2, s[28:31], s52 offen nt lds
    s_add_u32 s52, s52, 65536
    s_barrier
    s_lshl_b32 s66, s64, 3
    s_and_b32 s73, s2, 7
    s_or_b32 s66, s66, s73
    s_bfe_u32 s67, s2, 0x30003
    s_bfe_u32 s70, s2, 0x40003
    s_cmp_eq_u32 s72, 0
    s_cselect_b32 s32, s16, s18
    s_cselect_b32 s33, s17, s19
    s_mov_b32 s34, 7340032
    s_mov_b32 s35, 0x20000
    s_lshl_b32 s53, s71, 2
    s_add_u32 s53, s53, s3
    s_mul_i32 s53, s53, 229376
    s_mul_i32 s73, s70, 448
    s_add_u32 s53, s53, s73
    v_lshlrev_b32 v3, 4, v0
    v_add_u32 v4, 6720, v3
    v_cmp_gt_u32 vcc, 28, v0
    s_nop 1
    v_cndmask_b32 v3, v4, v3, vcc
    s_lshl_b32 s73, s3, 8
    s_add_u32 s73, s73, 131072
    v_lshl_add_u32 v8, v0, 2, s73
    s_mov_b32 s36, s6
    s_mov_b32 s37, s7
    s_mov_b32 s38, 67108864
    s_mov_b32 s39, 0x20000
    s_mov_b32 s44, s20
    s_mov_b32 s45, s21
    s_mov_b32 s46, 7340032
    s_mov_b32 s47, 0x20000
    s_mov_b32 s48, s12
    s_mov_b32 s49, s13
    s_mov_b32 s50, 8388608
    s_mov_b32 s51, 0x20000
    s_lshl_b32 s54, s65, 2
    s_add_u32 s54, s54, s3
    s_lshl_b32 s54, s54, 13
    s_lshl_b32 s73, s64, 24
    s_add_u32 s54, s54, s73
    s_lshl_b32 s56, s66, 2
    s_add_u32 s56, s56, s3
    s_lshl_b32 s73, s67, 8
    s_mul_i32 s55, s56, 57344
    s_add_u32 s55, s55, s73
    s_lshl_b32 s56, s56, 16
    s_add_u32 s56, s56, s73
    v_lshrrev_b32 v10, 4, v0
    v_and_b32 v11, 15, v0
    v_lshlrev_b32 v12, 1, v10
    v_xor_b32 v12, v11, v12
    v_xor_b32 v13, 8, v12
    v_lshlrev_b32 v12, 4, v12
    v_lshlrev_b32 v13, 4, v13
    v_lshl_or_b32 v4, v10, 8, v12
    v_lshl_or_b32 v5, v10, 8, v13
    v_lshl_or_b32 v6, v10, 11, v12
    v_lshl_or_b32 v7, v10, 11, v13
    v_mov_b32 v11, 131072
    s_lshr_b64 exec, -1, 8
    s_waitcnt vmcnt(5)
    s_add_u32 m0, s57, 8192
    s_nop 0
    buffer_load_dwordx4 v3, s[32:35], s53 offen nt lds
    s_add_u32 s53, s53, 14336
    s_waitcnt vmcnt(5)
    s_add_u32 m0, s57, 9088
    s_nop 0
    buffer_load_dwordx4 v3, s[32:35], s53 offen nt lds
    s_add_u32 s53, s53, 14336
    s_waitcnt vmcnt(5)
    s_add_u32 m0, s57, 9984
    s_nop 0
    buffer_load_dwordx4 v3, s[32:35], s53 offen nt lds
    s_add_u32 s53, s53, 14336
    s_waitcnt vmcnt(5)
    s_add_u32 m0, s57, 10880
    s_nop 0
    buffer_load_dwordx4 v3, s[32:35], s53 offen nt lds
    s_add_u32 s53, s53, 14336
    s_waitcnt vmcnt(5)
    s_add_u32 m0, s57, 11776
    s_nop 0
    buffer_load_dwordx4 v3, s[32:35], s53 offen nt lds
    s_add_u32 s53, s53, 14336
    s_waitcnt vmcnt(5)
    v_mov_b32 v9, 1
    ds_write_b32 v8, v9 offset:0
    s_add_u32 m0, s57, 12672
    s_nop 0
    buffer_load_dwordx4 v3, s[32:35], s53 offen nt lds
    s_add_u32 s53, s53, 14336
    s_waitcnt vmcnt(5)
    s_add_u32 m0, s57, 13568
    s_nop 0
    buffer_load_dwordx4 v3, s[32:35], s53 offen nt lds
    s_add_u32 s53, s53, 14336
    s_waitcnt vmcnt(5)
    s_add_u32 m0, s57, 14464
    s_nop 0
    buffer_load_dwordx4 v3, s[32:35], s53 offen nt lds
    s_add_u32 s53, s53, 14336
    s_waitcnt vmcnt(5)
    s_add_u32 m0, s57, 16384
    s_nop 0
    buffer_load_dwordx4 v3, s[32:35], s53 offen nt lds
    s_add_u32 s53, s53, 14336
    s_waitcnt vmcnt(5)
    s_add_u32 m0, s57, 17280
    s_nop 0
    buffer_load_dwordx4 v3, s[32:35], s53 offen nt lds
    s_add_u32 s53, s53, 14336
    s_waitcnt vmcnt(5)
    s_add_u32 m0, s57, 18176
    s_nop 0
    buffer_load_dwordx4 v3, s[32:35], s53 offen nt lds
    s_add_u32 s53, s53, 14336
    s_waitcnt vmcnt(5)
    s_add_u32 m0, s57, 19072
    s_nop 0
    buffer_load_dwordx4 v3, s[32:35], s53 offen nt lds
    s_add_u32 s53, s53, 14336
    s_waitcnt vmcnt(5)
    s_add_u32 m0, s57, 19968
    s_nop 0
    buffer_load_dwordx4 v3, s[32:35], s53 offen nt lds
    s_add_u32 s53, s53, 14336
    s_waitcnt vmcnt(5)
    v_mov_b32 v9, 2
    ds_write_b32 v8, v9 offset:0
    s_add_u32 m0, s57, 20864
    s_nop 0
    buffer_load_dwordx4 v3, s[32:35], s53 offen nt lds
    s_add_u32 s53, s53, 14336
    s_waitcnt vmcnt(5)
    s_add_u32 m0, s57, 21760
    s_nop 0
    buffer_load_dwordx4 v3, s[32:35], s53 offen nt lds
    s_add_u32 s53, s53, 14336
    s_waitcnt vmcnt(5)
    s_add_u32 m0, s57, 22656
    s_nop 0
    buffer_load_dwordx4 v3, s[32:35], s53 offen nt lds
    s_add_u32 s53, s53, 14336
    s_mov_b64 exec, -1
    s_mov_b32 s58, 3
    s_add_u32 s59, s57, 24576
    ds_read_b32 v10, v8 offset:1024
    ds_read_b32 v12, v11 offset:2088
L_lloop:
    s_waitcnt lgkmcnt(0)
    v_readfirstlane_b32 s77, v12
    v_readfirstlane_b32 s61, v10
    s_sub_u32 s75, s58, 3
    s_cmp_ge_i32 s61, s75
    s_cbranch_scc1 L_lok
Lsp_1:
    ds_read_b32 v10, v8 offset:1024
    s_waitcnt lgkmcnt(0)
    v_readfirstlane_b32 s61, v10
    s_cmp_ge_i32 s61, s75
    s_cbranch_scc1 Lsp_2
    s_sub_u32 s60, s60, 1
    s_cbranch_scc0 Lsp_1
    s_mov_b32 s60, 0
Lsp_2:
L_lok:
    s_mov_b32 m0, s59
    s_add_u32 s74, s54, 4096
    s_cmp_eq_u32 s77, 1
    s_cbranch_scc1 L_lb1
    s_cmp_eq_u32 s77, 2
    s_cbranch_scc1 L_lb2
L_lb0:
    s_waitcnt vmcnt(5)
    buffer_load_dwordx4 v4, s[36:39], s54 offen offset:0 nt lds
    s_waitcnt vmcnt(5)
    buffer_load_dwordx4 v5, s[36:39], s54 offen offset:1024 nt lds
    s_waitcnt vmcnt(5)
    buffer_load_dwordx4 v4, s[36:39], s54 offen offset:2048 nt lds
    s_waitcnt vmcnt(5)
    buffer_load_dwordx4 v5, s[36:39], s54 offen offset:3072 nt lds
    s_waitcnt vmcnt(5)
    s_add_u32 m0, s59, 4096
    s_nop 0
    buffer_load_dwordx4 v4, s[36:39], s74 offen offset:0 nt lds
    s_waitcnt vmcnt(5)
    v_mov_b32 v9, s58
    ds_write_b32 v8, v9 offset:0
    buffer_load_dwordx4 v5, s[36:39], s74 offen offset:1024 nt lds
    s_waitcnt vmcnt(5)
    buffer_load_dwordx4 v4, s[36:39], s74 offen offset:2048 nt lds
    s_waitcnt vmcnt(5)
    buffer_load_dwordx4 v5, s[36:39], s74 offen offset:3072 nt lds
    s_branch L_lnext
L_lb1:
    s_waitcnt vmcnt(4)
    buffer_load_dwordx4 v4, s[36:39], s54 offen offset:0 nt lds
    s_waitcnt vmcnt(4)
    buffer_load_dwordx4 v5, s[36:39], s54 offen offset:1024 nt lds
    s_waitcnt vmcnt(4)
    buffer_load_dwordx4 v4, s[36:39], s54 offen offset:2048 nt lds
    s_waitcnt vmcnt(4)
    buffer_load_dwordx4 v5, s[36:39], s54 offen offset:3072 nt lds
    s_waitcnt vmcnt(4)
    v_mov_b32 v9, s58
    ds_write_b32 v8, v9 offset:0
    s_add_u32 m0, s59, 4096
    s_nop 0
    buffer_load_dwordx4 v4, s[36:39], s74 offen offset:0 nt lds
    s_waitcnt vmcnt(4)
    buffer_load_dwordx4 v5, s[36:39], s74 offen offset:1024 nt lds
    s_waitcnt vmcnt(4)
    buffer_load_dwordx4 v4, s[36:39], s74 offen offset:2048 nt lds
    s_waitcnt vmcnt(4)
    buffer_load_dwordx4 v5, s[36:39], s74 offen offset:3072 nt lds
    s_branch L_lnext
L_lb2:
    s_waitcnt vmcnt(6)
    buffer_load_dwordx4 v4, s[36:39], s54 offen offset:0 nt lds
    s_waitcnt vmcnt(6)
    buffer_load_dwordx4 v5, s[36:39], s54 offen offset:1024 nt lds
    s_waitcnt vmcnt(6)
    buffer_load_dwordx4 v4, s[36:39], s54 offen offset:2048 nt lds
    s_waitcnt vmcnt(6)
    buffer_load_dwordx4 v5, s[36:39], s54 offen offset:3072 nt lds
    s_waitcnt vmcnt(6)
    s_add_u32 m0, s59, 4096
    s_nop 0
    buffer_load_dwordx4 v4, s[36:39], s74 offen offset:0 nt lds
    s_waitcnt vmcnt(6)
    buffer_load_dwordx4 v5, s[36:39], s74 offen offset:1024 nt lds
    s_waitcnt vmcnt(6)
    v_mov_b32 v9, s58
    ds_write_b32 v8, v9 offset:0
    buffer_load_dwordx4 v4, s[36:39], s74 offen offset:2048 nt lds
    s_waitcnt vmcnt(6)
    buffer_load_dwordx4 v5, s[36:39], s74 offen offset:3072 nt lds
L_lnext:
    ds_read_b32 v12, v11 offset:2088
    ds_read_b32 v10, v8 offset:1024
    s_add_u32 s58, s58, 1
    s_and_b32 s59, s58, 3
    s_lshl_b32 s59, s59, 13
    s_add_u32 s59, s59, s57
    s_cmp_eq_u32 s58, 11
    s_cselect_b32 s36, s8, s36
    s_cselect_b32 s37, s9, s37
    s_cselect_b32 s73, 16777216, 0
    s_sub_u32 s54, s54, s73
    s_add_u32 s54, s54, 2097152
    s_cmp_lt_u32 s58, 19
    s_cbranch_scc1 L_lloop
    ds_read_b32 v12, v11 offset:2072
    s_waitcnt lgkmcnt(0)
    v_readfirstlane_b32 s77, v12
    s_cmp_lg_u32 s77, 1
    s_cbranch_scc1 L_lnot0
    s_waitcnt lgkmcnt(0)
    v_readfirstlane_b32 s61, v10
    s_cmp_ge_i32 s61, 16
    s_cbranch_scc1 Lok_3
Lsp_4:
    ds_read_b32 v10, v8 offset:1024
    s_waitcnt lgkmcnt(0)
    v_readfirstlane_b32 s61, v10
    s_cmp_ge_i32 s61, 16
    s_cbranch_scc1 Lsp_5
    s_sub_u32 s60, s60, 1
    s_cbranch_scc0 Lsp_4
    s_mov_b32 s60, 0
Lsp_5:
Lok_3:
    s_waitcnt vmcnt(4)
    s_add_u32 m0, s57, 24576
    s_nop 0
    buffer_load_dwordx4 v6, s[44:47], s55 offen nt lds
    s_add_u32 s55, s55, 8192
    s_waitcnt vmcnt(4)
    s_add_u32 m0, s57, 25600
    s_nop 0
    buffer_load_dwordx4 v7, s[44:47], s55 offen nt lds
    s_add_u32 s55, s55, 8192
    s_waitcnt vmcnt(4)
    s_add_u32 m0, s57, 26624
    s_nop 0
    buffer_load_dwordx4 v6, s[44:47], s55 offen nt lds
    s_add_u32 s55, s55, 8192
    s_waitcnt vmcnt(4)
    s_add_u32 m0, s57, 27648
    s_nop 0
    buffer_load_dwordx4 v7, s[44:47], s55 offen nt lds
    s_add_u32 s55, s55, 8192
    s_waitcnt vmcnt(4)
    v_mov_b32 v9, 19
    ds_write_b32 v8, v9 offset:0
    s_add_u32 m0, s57, 28672
    s_nop 0
    buffer_load_dwordx4 v6, s[44:47], s55 offen nt lds
    s_add_u32 s55, s55, 8192
    s_waitcnt vmcnt(4)
    s_add_u32 m0, s57, 29696
    s_nop 0
    buffer_load_dwordx4 v7, s[44:47], s55 offen nt lds
    s_add_u32 s55, s55, 8192
    s_waitcnt vmcnt(4)
    s_add_u32 m0, s57, 30720
    s_nop 0
    buffer_load_dwordx4 v6, s[44:47], s55 offen nt lds
    s_add_u32 s55, s55, 8192
    ds_read_b32 v10, v8 offset:1024
    s_waitcnt lgkmcnt(0)
    v_readfirstlane_b32 s61, v10
    s_cmp_ge_i32 s61, 17
    s_cbranch_scc1 Lok_6
Lsp_7:
    ds_read_b32 v10, v8 offset:1024
    s_waitcnt lgkmcnt(0)
    v_readfirstlane_b32 s61, v10
    s_cmp_ge_i32 s61, 17
    s_cbranch_scc1 Lsp_8
    s_sub_u32 s60, s60, 1
    s_cbranch_scc0 Lsp_7
    s_mov_b32 s60, 0
Lsp_8:
Lok_6:
    s_waitcnt vmcnt(4)
    s_add_u32 m0, s57, 0
    s_nop 0
    buffer_load_dwordx4 v6, s[48:51], s56 offen nt lds
    s_add_u32 s56, s56, 8192
    s_waitcnt vmcnt(4)
    s_add_u32 m0, s57, 1024
    s_nop 0
    buffer_load_dwordx4 v7, s[48:51], s56 offen nt lds
    s_add_u32 s56, s56, 8192
    s_waitcnt vmcnt(4)
    s_add_u32 m0, s57, 2048
    s_nop 0
    buffer_load_dwordx4 v6, s[48:51], s56 offen nt lds
    s_add_u32 s56, s56, 8192
    s_waitcnt vmcnt(4)
    s_add_u32 m0, s57, 3072
    s_nop 0
    buffer_load_dwordx4 v7, s[48:51], s56 offen nt lds
    s_add_u32 s56, s56, 8192
    s_waitcnt vmcnt(4)
    v_mov_b32 v9, 20
    ds_write_b32 v8, v9 offset:0
    s_add_u32 m0, s57, 4096
    s_nop 0
    buffer_load_dwordx4 v6, s[48:51], s56 offen nt lds
    s_add_u32 s56, s56, 8192
    s_waitcnt vmcnt(4)
    s_add_u32 m0, s57, 5120
    s_nop 0
    buffer_load_dwordx4 v7, s[48:51], s56 offen nt lds
    s_add_u32 s56, s56, 8192
    s_waitcnt vmcnt(4)
    s_add_u32 m0, s57, 6144
    s_nop 0
    buffer_load_dwordx4 v6, s[48:51], s56 offen nt lds
    s_add_u32 s56, s56, 8192
    s_waitcnt vmcnt(4)
    s_add_u32 m0, s57, 7168
    s_nop 0
    buffer_load_dwordx4 v7, s[48:51], s56 offen nt lds
    s_add_u32 s56, s56, 8192
    s_waitcnt vmcnt(0)
    v_mov_b32 v9, 21
    ds_write_b32 v8, v9 offset:0
    s_endpgm
L_lnot0:
    s_waitcnt lgkmcnt(0)
    v_readfirstlane_b32 s61, v10
    s_cmp_ge_i32 s61, 16
    s_cbranch_scc1 Lok_9
Lsp_10:
    ds_read_b32 v10, v8 offset:1024
    s_waitcnt lgkmcnt(0)
    v_readfirstlane_b32 s61, v10
    s_cmp_ge_i32 s61, 16
    s_cbranch_scc1 Lsp_11
    s_sub_u32 s60, s60, 1
    s_cbranch_scc0 Lsp_10
    s_mov_b32 s60, 0
Lsp_11:
Lok_9:
    s_waitcnt vmcnt(11)
    s_add_u32 m0, s57, 24576
    s_nop 0
    buffer_load_dwordx4 v6, s[44:47], s55 offen nt lds
    s_add_u32 s55, s55, 8192
    s_waitcnt vmcnt(11)
    s_add_u32 m0, s57, 25600
    s_nop 0
    buffer_load_dwordx4 v7, s[44:47], s55 offen nt lds
    s_add_u32 s55, s55, 8192
    s_waitcnt vmcnt(11)
    s_add_u32 m0, s57, 26624
    s_nop 0
    buffer_load_dwordx4 v6, s[44:47], s55 offen nt lds
    s_add_u32 s55, s55, 8192
    s_waitcnt vmcnt(11)
    s_add_u32 m0, s57, 27648
    s_nop 0
    buffer_load_dwordx4 v7, s[44:47], s55 offen nt lds
    s_add_u32 s55, s55, 8192
    s_waitcnt vmcnt(11)
    s_add_u32 m0, s57, 28672
    s_nop 0
    buffer_load_dwordx4 v6, s[44:47], s55 offen nt lds
    s_add_u32 s55, s55, 8192
    s_waitcnt vmcnt(11)
    s_add_u32 m0, s57, 29696
    s_nop 0
    buffer_load_dwordx4 v7, s[44:47], s55 offen nt lds
    s_add_u32 s55, s55, 8192
    s_waitcnt vmcnt(11)
    s_add_u32 m0, s57, 30720
    s_nop 0
    buffer_load_dwordx4 v6, s[44:47], s55 offen nt lds
    s_add_u32 s55, s55, 8192
    ds_read_b32 v10, v8 offset:1024
    s_waitcnt lgkmcnt(0)
    v_readfirstlane_b32 s61, v10
    s_cmp_ge_i32 s61, 17
    s_cbranch_scc1 Lok_12
Lsp_13:
    ds_read_b32 v10, v8 offset:1024
    s_waitcnt lgkmcnt(0)
    v_readfirstlane_b32 s61, v10
    s_cmp_ge_i32 s61, 17
    s_cbranch_scc1 Lsp_14
    s_sub_u32 s60, s60, 1
    s_cbranch_scc0 Lsp_13
    s_mov_b32 s60, 0
Lsp_14:
Lok_12:
    s_waitcnt vmcnt(11)
    s_add_u32 m0, s57, 0
    s_nop 0
    buffer_load_dwordx4 v6, s[48:51], s56 offen nt lds
    s_add_u32 s56, s56, 8192
    s_waitcnt vmcnt(11)
    s_add_u32 m0, s57, 1024
    s_nop 0
    buffer_load_dwordx4 v7, s[48:51], s56 offen nt lds
    s_add_u32 s56, s56, 8192
    s_waitcnt vmcnt(11)
    s_add_u32 m0, s57, 2048
    s_nop 0
    buffer_load_dwordx4 v6, s[48:51], s56 offen nt lds
    s_add_u32 s56, s56, 8192
    s_waitcnt vmcnt(11)
    s_add_u32 m0, s57, 3072
    s_nop 0
    buffer_load_dwordx4 v7, s[48:51], s56 offen nt lds
    s_add_u32 s56, s56, 8192
    s_waitcnt vmcnt(11)
    v_mov_b32 v9, 19
    ds_write_b32 v8, v9 offset:0
    s_add_u32 m0, s57, 4096
    s_nop 0
    buffer_load_dwordx4 v6, s[48:51], s56 offen nt lds
    s_add_u32 s56, s56, 8192
    s_waitcnt vmcnt(11)
    s_add_u32 m0, s57, 5120
    s_nop 0
    buffer_load_dwordx4 v7, s[48:51], s56 offen nt lds
    s_add_u32 s56, s56, 8192
    s_waitcnt vmcnt(11)
    s_add_u32 m0, s57, 6144
    s_nop 0
    buffer_load_dwordx4 v6, s[48:51], s56 offen nt lds
    s_add_u32 s56, s56, 8192
    s_waitcnt vmcnt(11)
    s_add_u32 m0, s57, 7168
    s_nop 0
    buffer_load_dwordx4 v7, s[48:51], s56 offen nt lds
    s_add_u32 s56, s56, 8192
    s_waitcnt vmcnt(8)
    v_mov_b32 v9, 20
    ds_write_b32 v8, v9 offset:0
    s_waitcnt vmcnt(0)
    v_mov_b32 v9, 21
    ds_write_b32 v8, v9 offset:0
    s_endpgm
L_C:
    s_setprio 2
    s_lshl_b32 s66, s64, 3
    s_and_b32 s73, s2, 7
    s_or_b32 s66, s66, s73
    s_bfe_u32 s67, s2, 0x30003
    s_bfe_u32 s70, s2, 0x40003
    s_mov_b32 s28, s26
    s_mov_b32 s29, s27
    s_mov_b32 s30, 268435456
    s_mov_b32 s31, 0x20000
    s_lshl_b32 s46, s76, 15
    s_lshl_b32 s73, s76, 8
    s_add_u32 s73, s73, 131072
    v_lshl_add_u32 v1, v0, 2, s73
    v_mov_b32 v2, 131072
    v_mov_b32 v124, 1
    v_mov_b32 v125, v106
    v_mov_b32 v126, v107
    v_lshrrev_b32 v104, 4, v0
    v_bfe_u32 v119, v0, 2, 2
    v_and_b32 v118, 3, v0
    v_lshlrev_b32 v118, 3, v118
    v_lshl_add_u32 v122, v104, 3, v119
    v_lshl_add_u32 v122, v122, 7, v118
    v_add_u32 v122, s46, v122
    s_lshl_b32 s73, s76, 8
    s_add_u32 s73, s73, 134144
    v_add_u32 v112, s73, v125
    s_waitcnt vmcnt(3)
    v_lshlrev_b32 v72, 16, v64
    v_and_b32 v73, 0xffff0000, v64
    v_lshlrev_b32 v74, 16, v65
    v_and_b32 v75, 0xffff0000, v65
    v_lshlrev_b32 v76, 16, v66
    v_and_b32 v77, 0xffff0000, v66
    v_lshlrev_b32 v78, 16, v67
    v_and_b32 v79, 0xffff0000, v67
    v_lshlrev_b32 v80, 16, v68
    v_and_b32 v81, 0xffff0000, v68
    v_lshlrev_b32 v82, 16, v69
    v_and_b32 v83, 0xffff0000, v69
    v_lshlrev_b32 v84, 16, v70
    v_and_b32 v85, 0xffff0000, v70
    v_lshlrev_b32 v86, 16, v71
    v_and_b32 v87, 0xffff0000, v71
    v_readfirstlane_b32 s42, v72
    s_nop 1
    v_mov_b32 v64, s42
    v_pk_add_f32 v[72:73], v[72:73], v[64:65] op_sel_hi:[1,0] neg_lo:[0,1] neg_hi:[0,1]
    v_pk_add_f32 v[74:75], v[74:75], v[64:65] op_sel_hi:[1,0] neg_lo:[0,1] neg_hi:[0,1]
    v_pk_add_f32 v[76:77], v[76:77], v[64:65] op_sel_hi:[1,0] neg_lo:[0,1] neg_hi:[0,1]
    v_pk_add_f32 v[78:79], v[78:79], v[64:65] op_sel_hi:[1,0] neg_lo:[0,1] neg_hi:[0,1]
    v_pk_add_f32 v[80:81], v[80:81], v[64:65] op_sel_hi:[1,0] neg_lo:[0,1] neg_hi:[0,1]
    v_pk_add_f32 v[82:83], v[82:83], v[64:65] op_sel_hi:[1,0] neg_lo:[0,1] neg_hi:[0,1]
    v_pk_add_f32 v[84:85], v[84:85], v[64:65] op_sel_hi:[1,0] neg_lo:[0,1] neg_hi:[0,1]
    v_pk_add_f32 v[86:87], v[86:87], v[64:65] op_sel_hi:[1,0] neg_lo:[0,1] neg_hi:[0,1]
    v_pk_mul_f32 v[66:67], v[72:73], v[72:73]
    v_pk_add_f32 v[68:69], v[72:73], v[74:75]
    v_pk_fma_f32 v[66:67], v[74:75], v[74:75], v[66:67]
    v_pk_add_f32 v[68:69], v[68:69], v[76:77]
    v_pk_fma_f32 v[66:67], v[76:77], v[76:77], v[66:67]
    v_pk_add_f32 v[68:69], v[68:69], v[78:79]
    v_pk_fma_f32 v[66:67], v[78:79], v[78:79], v[66:67]
    v_pk_add_f32 v[68:69], v[68:69], v[80:81]
    v_pk_fma_f32 v[66:67], v[80:81], v[80:81], v[66:67]
    v_pk_add_f32 v[68:69], v[68:69], v[82:83]
    v_pk_fma_f32 v[66:67], v[82:83], v[82:83], v[66:67]
    v_pk_add_f32 v[68:69], v[68:69], v[84:85]
    v_pk_fma_f32 v[66:67], v[84:85], v[84:85], v[66:67]
    v_pk_add_f32 v[68:69], v[68:69], v[86:87]
    v_pk_fma_f32 v[66:67], v[86:87], v[86:87], v[66:67]
    v_add_f32 v68, v68, v69
    v_add_f32 v66, v66, v67
    s_nop 0
    v_add_f32_dpp v68, v68, v68 quad_perm:[1,0,3,2] row_mask:0xf bank_mask:0xf
    v_add_f32_dpp v66, v66, v66 quad_perm:[1,0,3,2] row_mask:0xf bank_mask:0xf
    s_nop 0
    v_add_f32_dpp v68, v68, v68 quad_perm:[2,3,0,1] row_mask:0xf bank_mask:0xf
    v_add_f32_dpp v66, v66, v66 quad_perm:[2,3,0,1] row_mask:0xf bank_mask:0xf
    s_nop 0
    v_add_f32_dpp v68, v68, v68 row_half_mirror row_mask:0xf bank_mask:0xf
    v_add_f32_dpp v66, v66, v66 row_half_mirror row_mask:0xf bank_mask:0xf
    s_nop 0
    v_add_f32_dpp v68, v68, v68 row_mirror row_mask:0xf bank_mask:0xf
    v_add_f32_dpp v66, v66, v66 row_mirror row_mask:0xf bank_mask:0xf
    v_mov_b32 v69, v68
    v_mov_b32 v67, v66
    s_nop 0
    v_permlane16_swap_b32 v68, v69
    v_permlane16_swap_b32 v66, v67
    v_add_f32 v68, v68, v69
    v_add_f32 v66, v66, v67
    v_mov_b32 v69, v68
    v_mov_b32 v67, v66
    s_nop 0
    v_permlane32_swap_b32 v68, v69
    v_permlane32_swap_b32 v66, v67
    v_add_f32 v68, v68, v69
    v_add_f32 v66, v66, v67
    v_mul_f32 v68, 0x3a800000, v68
    v_mul_f32 v66, 0x3a800000, v66
    v_add_f32 v64, v64, v68
    v_fma_f32 v66, -v68, v68, v66
    v_max_f32 v66, 0, v66
    v_cvt_pk_bf16_f32 v64, v64, v64
    v_cvt_pk_bf16_f32 v66, v66, v66
    v_and_b32 v64, 0xffff0000, v64
    v_and_b32 v66, 0xffff0000, v66
    v_add_f32 v66, 0x3727c5ac, v66
    v_cvt_pk_bf16_f32 v66, v66, v66
    v_and_b32 v66, 0xffff0000, v66
    v_sqrt_f32 v66, v66
    s_nop 0
    v_cvt_pk_bf16_f32 v66, v66, v66
    v_and_b32 v66, 0xffff0000, v66
    v_rcp_f32 v68, v66
    s_waitcnt vmcnt(1)
    v_lshlrev_b32 v72, 16, v128
    v_and_b32 v73, 0xffff0000, v128
    v_pk_add_f32 v[72:73], v[72:73], v[64:65] op_sel_hi:[1,0] neg_lo:[0,1] neg_hi:[0,1]
    v_cvt_pk_bf16_f32 v74, v72, v73
    v_lshlrev_b32 v72, 16, v74
    v_and_b32 v73, 0xffff0000, v74
    v_pk_mul_f32 v[74:75], v[72:73], v[68:69] op_sel_hi:[1,0]
    v_pk_fma_f32 v[72:73], v[74:75], v[66:67], v[72:73] op_sel_hi:[1,0,1] neg_lo:[1,0,0] neg_hi:[1,0,0]
    v_pk_fma_f32 v[74:75], v[72:73], v[68:69], v[74:75] op_sel_hi:[1,0,1]
    v_cvt_pk_bf16_f32 v128, v74, v75
    v_lshlrev_b32 v72, 16, v129
    v_and_b32 v73, 0xffff0000, v129
    v_pk_add_f32 v[72:73], v[72:73], v[64:65] op_sel_hi:[1,0] neg_lo:[0,1] neg_hi:[0,1]
    v_cvt_pk_bf16_f32 v74, v72, v73
    v_lshlrev_b32 v72, 16, v74
    v_and_b32 v73, 0xffff0000, v74
    v_pk_mul_f32 v[74:75], v[72:73], v[68:69] op_sel_hi:[1,0]
    v_pk_fma_f32 v[72:73], v[74:75], v[66:67], v[72:73] op_sel_hi:[1,0,1] neg_lo:[1,0,0] neg_hi:[1,0,0]
    v_pk_fma_f32 v[74:75], v[72:73], v[68:69], v[74:75] op_sel_hi:[1,0,1]
    v_cvt_pk_bf16_f32 v129, v74, v75
    v_lshlrev_b32 v72, 16, v130
    v_and_b32 v73, 0xffff0000, v130
    v_pk_add_f32 v[72:73], v[72:73], v[64:65] op_sel_hi:[1,0] neg_lo:[0,1] neg_hi:[0,1]
    v_cvt_pk_bf16_f32 v74, v72, v73
    v_lshlrev_b32 v72, 16, v74
    v_and_b32 v73, 0xffff0000, v74
    v_pk_mul_f32 v[74:75], v[72:73], v[68:69] op_sel_hi:[1,0]
    v_pk_fma_f32 v[72:73], v[74:75], v[66:67], v[72:73] op_sel_hi:[1,0,1] neg_lo:[1,0,0] neg_hi:[1,0,0]
    v_pk_fma_f32 v[74:75], v[72:73], v[68:69], v[74:75] op_sel_hi:[1,0,1]
    v_cvt_pk_bf16_f32 v130, v74, v75
    v_lshlrev_b32 v72, 16, v131
    v_and_b32 v73, 0xffff0000, v131
    v_pk_add_f32 v[72:73], v[72:73], v[64:65] op_sel_hi:[1,0] neg_lo:[0,1] neg_hi:[0,1]
    v_cvt_pk_bf16_f32 v74, v72, v73
    v_lshlrev_b32 v72, 16, v74
    v_and_b32 v73, 0xffff0000, v74
    v_pk_mul_f32 v[74:75], v[72:73], v[68:69] op_sel_hi:[1,0]
    v_pk_fma_f32 v[72:73], v[74:75], v[66:67], v[72:73] op_sel_hi:[1,0,1] neg_lo:[1,0,0] neg_hi:[1,0,0]
    v_pk_fma_f32 v[74:75], v[72:73], v[68:69], v[74:75] op_sel_hi:[1,0,1]
    v_cvt_pk_bf16_f32 v131, v74, v75
    v_lshlrev_b32 v72, 16, v132
    v_and_b32 v73, 0xffff0000, v132
    v_pk_add_f32 v[72:73], v[72:73], v[64:65] op_sel_hi:[1,0] neg_lo:[0,1] neg_hi:[0,1]
    v_cvt_pk_bf16_f32 v74, v72, v73
    v_lshlrev_b32 v72, 16, v74
    v_and_b32 v73, 0xffff0000, v74
    v_pk_mul_f32 v[74:75], v[72:73], v[68:69] op_sel_hi:[1,0]
    v_pk_fma_f32 v[72:73], v[74:75], v[66:67], v[72:73] op_sel_hi:[1,0,1] neg_lo:[1,0,0] neg_hi:[1,0,0]
    v_pk_fma_f32 v[74:75], v[72:73], v[68:69], v[74:75] op_sel_hi:[1,0,1]
    v_cvt_pk_bf16_f32 v132, v74, v75
    v_lshlrev_b32 v72, 16, v133
    v_and_b32 v73, 0xffff0000, v133
    v_pk_add_f32 v[72:73], v[72:73], v[64:65] op_sel_hi:[1,0] neg_lo:[0,1] neg_hi:[0,1]
    v_cvt_pk_bf16_f32 v74, v72, v73
    v_lshlrev_b32 v72, 16, v74
    v_and_b32 v73, 0xffff0000, v74
    v_pk_mul_f32 v[74:75], v[72:73], v[68:69] op_sel_hi:[1,0]
    v_pk_fma_f32 v[72:73], v[74:75], v[66:67], v[72:73] op_sel_hi:[1,0,1] neg_lo:[1,0,0] neg_hi:[1,0,0]
    v_pk_fma_f32 v[74:75], v[72:73], v[68:69], v[74:75] op_sel_hi:[1,0,1]
    v_cvt_pk_bf16_f32 v133, v74, v75
    v_lshlrev_b32 v72, 16, v134
    v_and_b32 v73, 0xffff0000, v134
    v_pk_add_f32 v[72:73], v[72:73], v[64:65] op_sel_hi:[1,0] neg_lo:[0,1] neg_hi:[0,1]
    v_cvt_pk_bf16_f32 v74, v72, v73
    v_lshlrev_b32 v72, 16, v74
    v_and_b32 v73, 0xffff0000, v74
    v_pk_mul_f32 v[74:75], v[72:73], v[68:69] op_sel_hi:[1,0]
    v_pk_fma_f32 v[72:73], v[74:75], v[66:67], v[72:73] op_sel_hi:[1,0,1] neg_lo:[1,0,0] neg_hi:[1,0,0]
    v_pk_fma_f32 v[74:75], v[72:73], v[68:69], v[74:75] op_sel_hi:[1,0,1]
    v_cvt_pk_bf16_f32 v134, v74, v75
    v_lshlrev_b32 v72, 16, v135
    v_and_b32 v73, 0xffff0000, v135
    v_pk_add_f32 v[72:73], v[72:73], v[64:65] op_sel_hi:[1,0] neg_lo:[0,1] neg_hi:[0,1]
    v_cvt_pk_bf16_f32 v74, v72, v73
    v_lshlrev_b32 v72, 16, v74
    v_and_b32 v73, 0xffff0000, v74
    v_pk_mul_f32 v[74:75], v[72:73], v[68:69] op_sel_hi:[1,0]
    v_pk_fma_f32 v[72:73], v[74:75], v[66:67], v[72:73] op_sel_hi:[1,0,1] neg_lo:[1,0,0] neg_hi:[1,0,0]
    v_pk_fma_f32 v[74:75], v[72:73], v[68:69], v[74:75] op_sel_hi:[1,0,1]
    v_cvt_pk_bf16_f32 v135, v74, v75
Lsp_15:
    ds_read_b32 v3, v1 offset:0
    s_waitcnt lgkmcnt(0)
    v_readfirstlane_b32 s61, v3
    s_cmp_ge_i32 s61, 1
    s_cbranch_scc1 Lsp_16
    s_sub_u32 s60, s60, 1
    s_cbranch_scc0 Lsp_15
    s_mov_b32 s60, 0
Lsp_16:
    ds_read_b64_tr_b16 v[76:77], v122 offset:0
    ds_read_b64_tr_b16 v[78:79], v122 offset:512
    ds_read_b64_tr_b16 v[80:81], v122 offset:32
    ds_read_b64_tr_b16 v[82:83], v122 offset:544
    ds_read_b64_tr_b16 v[84:85], v122 offset:64
    ds_read_b64_tr_b16 v[86:87], v122 offset:576
    ds_read_b64_tr_b16 v[88:89], v122 offset:96
    ds_read_b64_tr_b16 v[90:91], v122 offset:608
    s_waitcnt lgkmcnt(6)
    v_mfma_f32_16x16x32_bf16 v[32:35], v[76:79], v[128:131], 0
    ds_read_b64_tr_b16 v[92:93], v122 offset:4096
    ds_read_b64_tr_b16 v[94:95], v122 offset:4608
    s_waitcnt lgkmcnt(6)
    v_mfma_f32_16x16x32_bf16 v[36:39], v[80:83], v[128:131], 0
    ds_read_b64_tr_b16 v[76:77], v122 offset:4128
    ds_read_b64_tr_b16 v[78:79], v122 offset:4640
    s_waitcnt lgkmcnt(6)
    v_mfma_f32_16x16x32_bf16 v[40:43], v[84:87], v[128:131], 0
    ds_read_b64_tr_b16 v[80:81], v122 offset:4160
    ds_read_b64_tr_b16 v[82:83], v122 offset:4672
    s_waitcnt lgkmcnt(6)
    v_mfma_f32_16x16x32_bf16 v[44:47], v[88:91], v[128:131], 0
    ds_read_b64_tr_b16 v[84:85], v122 offset:4192
    ds_read_b64_tr_b16 v[86:87], v122 offset:4704
    s_waitcnt lgkmcnt(6)
    v_mfma_f32_16x16x32_bf16 v[32:35], v[92:95], v[132:135], v[32:35]
    s_waitcnt lgkmcnt(4)
    v_mfma_f32_16x16x32_bf16 v[36:39], v[76:79], v[132:135], v[36:39]
    s_waitcnt lgkmcnt(2)
    v_mfma_f32_16x16x32_bf16 v[40:43], v[80:83], v[132:135], v[40:43]
    s_waitcnt lgkmcnt(0)
    v_mov_b32 v3, 1
    ds_write_b32 v1, v3 offset:1024
    v_mfma_f32_16x16x32_bf16 v[44:47], v[84:87], v[132:135], v[44:47]
    s_mov_b32 exec_lo, 0x10001
    s_mov_b32 exec_hi, 0x10001
    ds_write_b128 v112, v[32:35] offset:0
    ds_write_b128 v112, v[36:39] offset:64
    ds_write_b128 v112, v[40:43] offset:128
    s_nop 2
    ds_write_b128 v112, v[44:47] offset:192
    s_mov_b64 exec, 1
    ds_add_u32 v2, v124 offset:2048
    s_mov_b64 exec, -1
    s_waitcnt vmcnt(0)
    v_lshlrev_b32 v72, 16, v136
    v_and_b32 v73, 0xffff0000, v136
    v_pk_add_f32 v[72:73], v[72:73], v[64:65] op_sel_hi:[1,0] neg_lo:[0,1] neg_hi:[0,1]
    v_cvt_pk_bf16_f32 v74, v72, v73
    v_lshlrev_b32 v72, 16, v74
    v_and_b32 v73, 0xffff0000, v74
    v_pk_mul_f32 v[74:75], v[72:73], v[68:69] op_sel_hi:[1,0]
    v_pk_fma_f32 v[72:73], v[74:75], v[66:67], v[72:73] op_sel_hi:[1,0,1] neg_lo:[1,0,0] neg_hi:[1,0,0]
    v_pk_fma_f32 v[74:75], v[72:73], v[68:69], v[74:75] op_sel_hi:[1,0,1]
    v_cvt_pk_bf16_f32 v136, v74, v75
    v_lshlrev_b32 v72, 16, v137
    v_and_b32 v73, 0xffff0000, v137
    v_pk_add_f32 v[72:73], v[72:73], v[64:65] op_sel_hi:[1,0] neg_lo:[0,1] neg_hi:[0,1]
    v_cvt_pk_bf16_f32 v74, v72, v73
    v_lshlrev_b32 v72, 16, v74
    v_and_b32 v73, 0xffff0000, v74
    v_pk_mul_f32 v[74:75], v[72:73], v[68:69] op_sel_hi:[1,0]
    v_pk_fma_f32 v[72:73], v[74:75], v[66:67], v[72:73] op_sel_hi:[1,0,1] neg_lo:[1,0,0] neg_hi:[1,0,0]
    v_pk_fma_f32 v[74:75], v[72:73], v[68:69], v[74:75] op_sel_hi:[1,0,1]
    v_cvt_pk_bf16_f32 v137, v74, v75
    v_lshlrev_b32 v72, 16, v138
    v_and_b32 v73, 0xffff0000, v138
    v_pk_add_f32 v[72:73], v[72:73], v[64:65] op_sel_hi:[1,0] neg_lo:[0,1] neg_hi:[0,1]
    v_cvt_pk_bf16_f32 v74, v72, v73
    v_lshlrev_b32 v72, 16, v74
    v_and_b32 v73, 0xffff0000, v74
    v_pk_mul_f32 v[74:75], v[72:73], v[68:69] op_sel_hi:[1,0]
    v_pk_fma_f32 v[72:73], v[74:75], v[66:67], v[72:73] op_sel_hi:[1,0,1] neg_lo:[1,0,0] neg_hi:[1,0,0]
    v_pk_fma_f32 v[74:75], v[72:73], v[68:69], v[74:75] op_sel_hi:[1,0,1]
    v_cvt_pk_bf16_f32 v138, v74, v75
    v_lshlrev_b32 v72, 16, v139
    v_and_b32 v73, 0xffff0000, v139
    v_pk_add_f32 v[72:73], v[72:73], v[64:65] op_sel_hi:[1,0] neg_lo:[0,1] neg_hi:[0,1]
    v_cvt_pk_bf16_f32 v74, v72, v73
    v_lshlrev_b32 v72, 16, v74
    v_and_b32 v73, 0xffff0000, v74
    v_pk_mul_f32 v[74:75], v[72:73], v[68:69] op_sel_hi:[1,0]
    v_pk_fma_f32 v[72:73], v[74:75], v[66:67], v[72:73] op_sel_hi:[1,0,1] neg_lo:[1,0,0] neg_hi:[1,0,0]
    v_pk_fma_f32 v[74:75], v[72:73], v[68:69], v[74:75] op_sel_hi:[1,0,1]
    v_cvt_pk_bf16_f32 v139, v74, v75
    s_mul_i32 s84, s79, 0x9e3779b1
    s_add_u32 s84, s84, 0x7f4a7c15
    s_and_b32 s80, s84, 0x3ff
    s_add_u32 s81, s80, 256
    s_and_b32 s81, s81, 0x3ff
    s_add_u32 s82, s80, 512
    s_and_b32 s82, s82, 0x3ff
    s_add_u32 s83, s80, 768
    s_and_b32 s83, s83, 0x3ff
    v_mov_b32 v166, 0x3ff
    v_and_b32 v123, 1, v104
    v_lshl_add_u32 v123, v123, 3, v119
    v_mul_u32_u24 v123, 448, v123
    v_lshrrev_b32 v119, 5, v0
    v_lshl_add_u32 v123, v119, 13, v123
    s_add_u32 s73, s46, 8192
    v_add3_u32 v123, v123, v118, s73
    s_mul_i32 s73, s76, 896
    s_add_u32 s73, s73, 139264
    v_add_u32 v122, s73, v125
    v_and_b32 v113, 15, v0
    v_and_b32 v114, 7, v0
    v_lshlrev_b32 v127, 4, v114
    v_lshlrev_b32 v114, 1, v114
    v_lshlrev_b32 v115, 8, v113
    s_add_u32 s73, s46, 24576
    v_add_u32 v115, s73, v115
    v_add_u32 v116, 0, v104
    v_xor_b32 v116, v116, v114
    v_lshl_add_u32 v4, v116, 4, v115
    v_add_u32 v116, 4, v104
    v_xor_b32 v116, v116, v114
    v_lshl_add_u32 v5, v116, 4, v115
    v_add_u32 v116, 8, v104
    v_xor_b32 v116, v116, v114
    v_lshl_add_u32 v6, v116, 4, v115
    v_add_u32 v116, 12, v104
    v_xor_b32 v116, v116, v114
    v_lshl_add_u32 v7, v116, 4, v115
    v_lshrrev_b32 v116, 2, v0
    v_and_b32 v117, 7, v116
    v_lshl_add_u32 v116, v116, 8, v118
    v_add_u32 v116, s73, v116
    v_xor_b32 v119, 0, v117
    v_lshl_add_u32 v8, v119, 5, v116
    v_xor_b32 v119, 1, v117
    v_lshl_add_u32 v9, v119, 5, v116
    v_xor_b32 v119, 2, v117
    v_lshl_add_u32 v10, v119, 5, v116
    v_xor_b32 v119, 3, v117
    v_lshl_add_u32 v11, v119, 5, v116
    v_xor_b32 v119, 4, v117
    v_lshl_add_u32 v12, v119, 5, v116
    v_xor_b32 v119, 5, v117
    v_lshl_add_u32 v13, v119, 5, v116
    v_xor_b32 v119, 6, v117
    v_lshl_add_u32 v14, v119, 5, v116
    v_xor_b32 v119, 7, v117
    v_lshl_add_u32 v15, v119, 5, v116
    v_lshl_add_u32 v16, v127, 4, v125
    v_add_u32 v16, 135168, v16
    v_lshl_add_u32 v127, v125, 3, v127
    s_lshl_b32 s73, s76, 12
    s_add_u32 s73, s73, 143360
    v_add_u32 v127, s73, v127
    v_mov_b32 v120, 0xff800000
    v_mov_b32 v121, 0
    s_mov_b32 s49, 4
    s_mov_b32 s50, 0x3fb8aa3b
    s_mov_b32 s51, 0x3db504f3
    s_mov_b32 s52, 0x6000
    s_mov_b32 s53, 0
Lsp_17:
    ds_read_b32 v3, v1 offset:0
    s_waitcnt lgkmcnt(0)
    v_readfirstlane_b32 s61, v3
    s_cmp_ge_i32 s61, 3
    s_cbranch_scc1 Lsp_18
    s_sub_u32 s60, s60, 1
    s_cbranch_scc0 Lsp_17
    s_mov_b32 s60, 0
Lsp_18:
    ds_read_b64_tr_b16 v[64:65], v123 offset:0
    ds_read_b64_tr_b16 v[66:67], v123 offset:1792
    ds_read_b64_tr_b16 v[68:69], v123 offset:32
    ds_read_b64_tr_b16 v[70:71], v123 offset:1824
    ds_read_b64_tr_b16 v[72:73], v123 offset:64
    ds_read_b64_tr_b16 v[74:75], v123 offset:1856
    ds_read_b64_tr_b16 v[76:77], v123 offset:96
    ds_read_b64_tr_b16 v[78:79], v123 offset:1888
    ds_read_b64_tr_b16 v[80:81], v123 offset:128
    ds_read_b64_tr_b16 v[82:83], v123 offset:1920
    ds_read_b64_tr_b16 v[84:85], v123 offset:160
    ds_read_b64_tr_b16 v[86:87], v123 offset:1952
    ds_read_b64_tr_b16 v[88:89], v123 offset:192
    ds_read_b64_tr_b16 v[90:91], v123 offset:1984
    s_waitcnt lgkmcnt(12)
    v_mfma_f32_16x16x32_bf16 v[32:35], v[64:67], v[136:139], 0
    ds_read_b64_tr_b16 v[92:93], v123 offset:224
    ds_read_b64_tr_b16 v[94:95], v123 offset:2016
    s_waitcnt lgkmcnt(12)
    v_mfma_f32_16x16x32_bf16 v[36:39], v[68:71], v[136:139], 0
    ds_read_b64_tr_b16 v[64:65], v123 offset:256
    ds_read_b64_tr_b16 v[66:67], v123 offset:2048
    s_waitcnt lgkmcnt(12)
    v_mfma_f32_16x16x32_bf16 v[40:43], v[72:75], v[136:139], 0
    ds_read_b64_tr_b16 v[68:69], v123 offset:288
    ds_read_b64_tr_b16 v[70:71], v123 offset:2080
    s_waitcnt lgkmcnt(12)
    v_mfma_f32_16x16x32_bf16 v[44:47], v[76:79], v[136:139], 0
    ds_read_b64_tr_b16 v[72:73], v123 offset:320
    ds_read_b64_tr_b16 v[74:75], v123 offset:2112
    s_waitcnt lgkmcnt(12)
    v_mfma_f32_16x16x32_bf16 v[48:51], v[80:83], v[136:139], 0
    ds_read_b64_tr_b16 v[76:77], v123 offset:352
    ds_read_b64_tr_b16 v[78:79], v123 offset:2144
    s_waitcnt lgkmcnt(12)
    v_mfma_f32_16x16x32_bf16 v[52:55], v[84:87], v[136:139], 0
    ds_read_b64_tr_b16 v[80:81], v123 offset:384
    ds_read_b64_tr_b16 v[82:83], v123 offset:2176
    s_waitcnt lgkmcnt(12)
    v_mfma_f32_16x16x32_bf16 v[56:59], v[88:91], v[136:139], 0
    ds_read_b64_tr_b16 v[84:85], v123 offset:416
    ds_read_b64_tr_b16 v[86:87], v123 offset:2208
    s_waitcnt lgkmcnt(12)
    v_mfma_f32_16x16x32_bf16 v[60:63], v[92:95], v[136:139], 0
    s_waitcnt lgkmcnt(10)
    v_mfma_f32_16x16x32_bf16 v[96:99], v[64:67], v[136:139], 0
    s_waitcnt lgkmcnt(8)
    v_mfma_f32_16x16x32_bf16 v[100:103], v[68:71], v[136:139], 0
    s_waitcnt lgkmcnt(6)
    v_mfma_f32_16x16x32_bf16 v[104:107], v[72:75], v[136:139], 0
    s_waitcnt lgkmcnt(4)
    v_mfma_f32_16x16x32_bf16 v[108:111], v[76:79], v[136:139], 0
    s_waitcnt lgkmcnt(2)
    v_mfma_f32_16x16x32_bf16 v[112:115], v[80:83], v[136:139], 0
    s_waitcnt lgkmcnt(0)
    v_mov_b32 v3, 3
    ds_write_b32 v1, v3 offset:1024
    v_mfma_f32_16x16x32_bf16 v[116:119], v[84:87], v[136:139], 0
    s_mov_b32 exec_lo, 0x10001
    s_mov_b32 exec_hi, 0x10001
    ds_write_b128 v122, v[32:35] offset:0
    ds_write_b128 v122, v[36:39] offset:64
    ds_write_b128 v122, v[40:43] offset:128
    ds_write_b128 v122, v[44:47] offset:192
    ds_write_b128 v122, v[48:51] offset:256
    ds_write_b128 v122, v[52:55] offset:320
    ds_write_b128 v122, v[56:59] offset:384
    ds_write_b128 v122, v[60:63] offset:448
    ds_write_b128 v122, v[96:99] offset:512
    ds_write_b128 v122, v[100:103] offset:576
    ds_write_b128 v122, v[104:107] offset:640
    ds_write_b128 v122, v[108:111] offset:704
    ds_write_b128 v122, v[112:115] offset:768
    ds_write_b128 v122, v[116:119] offset:832
    s_mov_b64 exec, 1
    ds_add_u32 v2, v124 offset:2052
    s_mov_b64 exec, -1
Lsp_19:
    ds_read_b32 v3, v1 offset:0
    s_waitcnt lgkmcnt(0)
    v_readfirstlane_b32 s61, v3
    s_cmp_ge_i32 s61, s49
    s_cbranch_scc1 Lsp_20
    s_sub_u32 s60, s60, 1
    s_cbranch_scc0 Lsp_19
    s_mov_b32 s60, 0
Lsp_20:
    ds_read_b128 v[64:67], v4 offset:0
    ds_read_b128 v[68:71], v4 offset:4096
    ds_read_b128 v[72:75], v5 offset:0
    ds_read_b128 v[76:79], v5 offset:4096
    ds_read_b128 v[80:83], v6 offset:0
    ds_read_b128 v[84:87], v6 offset:4096
    ds_read_b128 v[88:91], v7 offset:0
    ds_read_b128 v[92:95], v7 offset:4096
    s_waitcnt lgkmcnt(0)
    v_mov_b32 v3, s49
    ds_write_b32 v1, v3 offset:1024
    v_xor_b32 v4, s52, v4
    v_xor_b32 v5, s52, v5
    v_xor_b32 v6, s52, v6
    v_xor_b32 v7, s52, v7
    s_xor_b32 s52, s52, 0x4000
    s_add_u32 s49, s49, 1
Lsp_21:
    ds_read_b32 v3, v1 offset:0
    s_waitcnt lgkmcnt(0)
    v_readfirstlane_b32 s61, v3
    s_cmp_ge_i32 s61, s49
    s_cbranch_scc1 Lsp_22
    s_sub_u32 s60, s60, 1
    s_cbranch_scc0 Lsp_21
    s_mov_b32 s60, 0
Lsp_22:
    ds_read_b128 v[128:131], v4 offset:0
    ds_read_b128 v[132:135], v4 offset:4096
    ds_read_b128 v[136:139], v5 offset:0
    ds_read_b128 v[140:143], v5 offset:4096
    ds_read_b128 v[144:147], v6 offset:0
    ds_read_b128 v[148:151], v6 offset:4096
    ds_read_b128 v[152:155], v7 offset:0
    ds_read_b128 v[156:159], v7 offset:4096
    s_waitcnt lgkmcnt(0)
    v_mov_b32 v3, s49
    ds_write_b32 v1, v3 offset:1024
    v_xor_b32 v4, s52, v4
    v_xor_b32 v5, s52, v5
    v_xor_b32 v6, s52, v6
    v_xor_b32 v7, s52, v7
    s_xor_b32 s52, s52, 0x4000
    s_add_u32 s49, s49, 1
Lsp_23:
    ds_read_b32 v3, v1 offset:0
    s_waitcnt lgkmcnt(0)
    v_readfirstlane_b32 s61, v3
    s_cmp_ge_i32 s61, s49
    s_cbranch_scc1 Lsp_24
    s_sub_u32 s60, s60, 1
    s_cbranch_scc0 Lsp_23
    s_mov_b32 s60, 0
Lsp_24:
    ds_read_b128 v[32:35], v4 offset:0
    ds_read_b128 v[36:39], v4 offset:4096
    ds_read_b128 v[40:43], v5 offset:0
    ds_read_b128 v[44:47], v5 offset:4096
    ds_read_b128 v[48:51], v6 offset:0
    ds_read_b128 v[52:55], v6 offset:4096
    ds_read_b128 v[56:59], v7 offset:0
    ds_read_b128 v[60:63], v7 offset:4096
    s_waitcnt lgkmcnt(0)
    v_mov_b32 v3, s49
    ds_write_b32 v1, v3 offset:1024
    v_xor_b32 v4, s52, v4
    v_xor_b32 v5, s52, v5
    v_xor_b32 v6, s52, v6
    v_xor_b32 v7, s52, v7
    s_xor_b32 s52, s52, 0x4000
    s_add_u32 s49, s49, 1
    v_mov_b32 v113, v16
Lsp_25:
    ds_read_b32 v3, v2 offset:2056
    s_waitcnt lgkmcnt(0)
    v_readfirstlane_b32 s61, v3
    s_cmp_ge_i32 s61, 1
    s_cbranch_scc1 Lsp_26
    s_sub_u32 s60, s60, 1
    s_cbranch_scc0 Lsp_25
    s_mov_b32 s60, 0
Lsp_26:
    ds_read_b128 v[16:19], v113 offset:0
    ds_read_b128 v[20:23], v113 offset:64
    ds_read_b128 v[24:27], v113 offset:128
    ds_read_b128 v[28:31], v113 offset:192
    s_waitcnt lgkmcnt(0)
L_c_qk:
    v_mfma_f32_16x16x32_bf16 v[96:99], v[64:67], v[16:19], 0
    v_mfma_f32_16x16x32_bf16 v[100:103], v[68:71], v[16:19], 0
    v_mfma_f32_16x16x32_bf16 v[96:99], v[72:75], v[20:23], v[96:99]
    v_mfma_f32_16x16x32_bf16 v[100:103], v[76:79], v[20:23], v[100:103]
    v_mfma_f32_16x16x32_bf16 v[96:99], v[80:83], v[24:27], v[96:99]
    v_mfma_f32_16x16x32_bf16 v[100:103], v[84:87], v[24:27], v[100:103]
    v_mfma_f32_16x16x32_bf16 v[96:99], v[88:91], v[28:31], v[96:99]
    v_mfma_f32_16x16x32_bf16 v[100:103], v[92:95], v[28:31], v[100:103]
    s_nop 6
    v_cvt_pk_bf16_f32 v104, v96, v97
    v_cvt_pk_bf16_f32 v105, v98, v99
    v_cvt_pk_bf16_f32 v106, v100, v101
    v_cvt_pk_bf16_f32 v107, v102, v103
    v_lshlrev_b32 v96, 16, v104
    v_and_b32 v97, 0xffff0000, v104
    v_lshlrev_b32 v98, 16, v105
    v_and_b32 v99, 0xffff0000, v105
    v_lshlrev_b32 v100, 16, v106
    v_and_b32 v101, 0xffff0000, v106
    v_lshlrev_b32 v102, 16, v107
    v_and_b32 v103, 0xffff0000, v107
    v_mul_f32 v96, s51, v96
    v_mul_f32 v97, s51, v97
    v_mul_f32 v98, s51, v98
    v_mul_f32 v99, s51, v99
    v_mul_f32 v100, s51, v100
    v_mul_f32 v101, s51, v101
    v_mul_f32 v102, s51, v102
    v_mul_f32 v103, s51, v103
    v_cvt_pk_bf16_f32 v104, v96, v97
    v_cvt_pk_bf16_f32 v105, v98, v99
    v_cvt_pk_bf16_f32 v106, v100, v101
    v_cvt_pk_bf16_f32 v107, v102, v103
    ds_write_b128 v127, v[104:107]
    v_add_u32 v127, 512, v127
    v_lshlrev_b32 v96, 16, v104
    v_and_b32 v97, 0xffff0000, v104
    v_lshlrev_b32 v98, 16, v105
    v_and_b32 v99, 0xffff0000, v105
    v_lshlrev_b32 v100, 16, v106
    v_and_b32 v101, 0xffff0000, v106
    v_lshlrev_b32 v102, 16, v107
    v_and_b32 v103, 0xffff0000, v107
    v_max3_f32 v120, v120, v96, v97
    v_max3_f32 v109, v98, v99, v100
    v_max3_f32 v120, v120, v101, v102
    v_max3_f32 v120, v120, v109, v103
    s_add_u32 s53, s53, 1
    s_cmp_le_u32 s53, 2
    s_cbranch_scc1 L_c_staged
    s_cmp_eq_u32 s53, 8
    s_cbranch_scc1 L_c_kdone
Lsp_27:
    ds_read_b32 v3, v1 offset:0
    s_waitcnt lgkmcnt(0)
    v_readfirstlane_b32 s61, v3
    s_cmp_ge_i32 s61, s49
    s_cbranch_scc1 Lsp_28
    s_sub_u32 s60, s60, 1
    s_cbranch_scc0 Lsp_27
    s_mov_b32 s60, 0
Lsp_28:
    ds_read_b128 v[64:67], v4 offset:0
    ds_read_b128 v[68:71], v4 offset:4096
    ds_read_b128 v[72:75], v5 offset:0
    ds_read_b128 v[76:79], v5 offset:4096
    ds_read_b128 v[80:83], v6 offset:0
    ds_read_b128 v[84:87], v6 offset:4096
    ds_read_b128 v[88:91], v7 offset:0
    ds_read_b128 v[92:95], v7 offset:4096
    s_waitcnt lgkmcnt(0)
    v_mov_b32 v3, s49
    ds_write_b32 v1, v3 offset:1024
    v_xor_b32 v4, s52, v4
    v_xor_b32 v5, s52, v5
    v_xor_b32 v6, s52, v6
    v_xor_b32 v7, s52, v7
    s_xor_b32 s52, s52, 0x4000
    s_add_u32 s49, s49, 1
    s_branch L_c_qk
L_c_staged:
    v_mov_b32 v64, v128
    v_mov_b32 v65, v129
    v_mov_b32 v66, v130
    v_mov_b32 v67, v131
    v_mov_b32 v68, v132
    v_mov_b32 v69, v133
    v_mov_b32 v70, v134
    v_mov_b32 v71, v135
    v_mov_b32 v72, v136
    v_mov_b32 v73, v137
    v_mov_b32 v74, v138
    v_mov_b32 v75, v139
    v_mov_b32 v76, v140
    v_mov_b32 v77, v141
    v_mov_b32 v78, v142
    v_mov_b32 v79, v143
    v_mov_b32 v80, v144
    v_mov_b32 v81, v145
    v_mov_b32 v82, v146
    v_mov_b32 v83, v147
    v_mov_b32 v84, v148
    v_mov_b32 v85, v149
    v_mov_b32 v86, v150
    v_mov_b32 v87, v151
    v_mov_b32 v88, v152
    v_mov_b32 v89, v153
    v_mov_b32 v90, v154
    v_mov_b32 v91, v155
    v_mov_b32 v92, v156
    v_mov_b32 v93, v157
    v_mov_b32 v94, v158
    v_mov_b32 v95, v159
    v_mov_b32 v128, v32
    v_mov_b32 v129, v33
    v_mov_b32 v130, v34
    v_mov_b32 v131, v35
    v_mov_b32 v132, v36
    v_mov_b32 v133, v37
    v_mov_b32 v134, v38
    v_mov_b32 v135, v39
    v_mov_b32 v136, v40
    v_mov_b32 v137, v41
    v_mov_b32 v138, v42
    v_mov_b32 v139, v43
    v_mov_b32 v140, v44
    v_mov_b32 v141, v45
    v_mov_b32 v142, v46
    v_mov_b32 v143, v47
    v_mov_b32 v144, v48
    v_mov_b32 v145, v49
    v_mov_b32 v146, v50
    v_mov_b32 v147, v51
    v_mov_b32 v148, v52
    v_mov_b32 v149, v53
    v_mov_b32 v150, v54
    v_mov_b32 v151, v55
    v_mov_b32 v152, v56
    v_mov_b32 v153, v57
    v_mov_b32 v154, v58
    v_mov_b32 v155, v59
    v_mov_b32 v156, v60
    v_mov_b32 v157, v61
    v_mov_b32 v158, v62
    v_mov_b32 v159, v63
    s_branch L_c_qk
L_c_kdone:
    v_mov_b32 v109, v120
    s_nop 1
    v_permlane16_swap_b32 v120, v109
    v_max_f32 v120, v120, v109
    v_mov_b32 v109, v120
    s_nop 1
    v_permlane32_swap_b32 v120, v109
    v_max_f32 v120, v120, v109
    v_mov_b32 v32, 0
    v_mov_b32 v33, 0
    v_mov_b32 v34, 0
    v_mov_b32 v35, 0
    v_mov_b32 v36, 0
    v_mov_b32 v37, 0
    v_mov_b32 v38, 0
    v_mov_b32 v39, 0
    v_mov_b32 v40, 0
    v_mov_b32 v41, 0
    v_mov_b32 v42, 0
    v_mov_b32 v43, 0
    v_mov_b32 v44, 0
    v_mov_b32 v45, 0
    v_mov_b32 v46, 0
    v_mov_b32 v47, 0
    v_mov_b32 v48, 0
    v_mov_b32 v49, 0
    v_mov_b32 v50, 0
    v_mov_b32 v51, 0
    v_mov_b32 v52, 0
    v_mov_b32 v53, 0
    v_mov_b32 v54, 0
    v_mov_b32 v55, 0
    v_mov_b32 v56, 0
    v_mov_b32 v57, 0
    v_mov_b32 v58, 0
    v_mov_b32 v59, 0
    v_mov_b32 v60, 0
    v_mov_b32 v61, 0
    v_mov_b32 v62, 0
    v_mov_b32 v63, 0
    v_mul_f32 v110, s50, v120
    v_subrev_u32 v127, 4096, v127
    s_mov_b32 s52, 0x6000
L_c_exp:
    ds_read_b128 v[104:107], v127
    s_waitcnt lgkmcnt(0)
    v_lshlrev_b32 v96, 16, v104
    v_and_b32 v97, 0xffff0000, v104
    v_lshlrev_b32 v98, 16, v105
    v_and_b32 v99, 0xffff0000, v105
    v_lshlrev_b32 v100, 16, v106
    v_and_b32 v101, 0xffff0000, v106
    v_lshlrev_b32 v102, 16, v107
    v_and_b32 v103, 0xffff0000, v107
    v_fma_f32 v96, v96, s50, -v110
    v_fma_f32 v97, v97, s50, -v110
    v_fma_f32 v98, v98, s50, -v110
    v_fma_f32 v99, v99, s50, -v110
    v_fma_f32 v100, v100, s50, -v110
    v_fma_f32 v101, v101, s50, -v110
    v_fma_f32 v102, v102, s50, -v110
    v_fma_f32 v103, v103, s50, -v110
    v_exp_f32 v96, v96
    v_exp_f32 v97, v97
    v_exp_f32 v98, v98
    v_exp_f32 v99, v99
    v_exp_f32 v100, v100
    v_exp_f32 v101, v101
    v_exp_f32 v102, v102
    v_exp_f32 v103, v103
    v_cvt_pk_bf16_f32 v104, v96, v97
    v_cvt_pk_bf16_f32 v105, v98, v99
    v_cvt_pk_bf16_f32 v106, v100, v101
    v_cvt_pk_bf16_f32 v107, v102, v103
    v_pk_add_f32 v[96:97], v[96:97], v[98:99]
    v_pk_add_f32 v[100:101], v[100:101], v[102:103]
    ds_write_b128 v127, v[104:107]
    v_pk_add_f32 v[96:97], v[96:97], v[100:101]
    v_add_u32 v127, 512, v127
    v_add_f32 v121, v121, v96
    v_add_f32 v121, v121, v97
    s_sub_u32 s53, s53, 1
    s_cmp_lg_u32 s53, 0
    s_cbranch_scc1 L_c_exp
    v_subrev_u32 v127, 4096, v127
    v_mov_b32 v109, v121
    s_nop 1
    v_permlane16_swap_b32 v121, v109
    v_add_f32 v121, v121, v109
    v_mov_b32 v109, v121
    s_nop 1
    v_permlane32_swap_b32 v121, v109
    v_add_f32 v121, v121, v109
    s_lshl_b32 s73, s76, 6
    s_add_u32 s73, s73, 137216
    v_lshl_add_u32 v112, v0, 3, s73
    s_mov_b32 exec_lo, 0xff
    s_mov_b32 exec_hi, 0x0
    ds_write_b64 v112, v[120:121]
    s_mov_b64 exec, 1
    ds_add_u32 v2, v124 offset:2060
    s_mov_b64 exec, -1
    v_lshrrev_b32 v113, 5, v0
    s_lshl_b32 s73, s76, 1
    v_add_u32 v113, s73, v113
    v_lshlrev_b32 v112, 3, v113
    v_add_u32 v112, 137216, v112
Lsp_29:
    ds_read_b32 v3, v2 offset:2060
    ds_read_b64 v[96:97], v112 offset:0
    ds_read_b64 v[98:99], v112 offset:64
    ds_read_b64 v[100:101], v112 offset:128
    ds_read_b64 v[102:103], v112 offset:192
    s_waitcnt lgkmcnt(0)
    v_readfirstlane_b32 s61, v3
    s_cmp_ge_i32 s61, 4
    s_cbranch_scc1 Lsp_30
    s_sub_u32 s60, s60, 1
    s_cbranch_scc0 Lsp_29
    s_mov_b32 s60, 0
Lsp_30:
    v_max3_f32 v104, v96, v98, v100
    v_max_f32 v104, v104, v102
    v_sub_f32 v160, v96, v104
    v_mul_f32 v160, s50, v160
    v_sub_f32 v161, v98, v104
    v_mul_f32 v161, s50, v161
    v_sub_f32 v162, v100, v104
    v_mul_f32 v162, s50, v162
    v_sub_f32 v163, v102, v104
    v_mul_f32 v163, s50, v163
    v_exp_f32 v160, v160
    v_exp_f32 v161, v161
    v_exp_f32 v162, v162
    v_exp_f32 v163, v163
    s_cmp_lg_u32 s76, 0
    s_cbranch_scc1 L_c_noml
    v_lshl_add_u32 v112, v0, 3, v2
    v_mov_b32 v106, 0
    v_mov_b32 v107, 0
    s_lshl_b32 s47, s2, 7
    s_add_u32 s47, s47, 393216
    s_mov_b32 exec_lo, 0xff
    s_mov_b32 exec_hi, 0x0
    ds_read_b64 v[96:97], v112 offset:6144
    ds_read_b64 v[98:99], v112 offset:6208
    ds_read_b64 v[100:101], v112 offset:6272
    ds_read_b64 v[102:103], v112 offset:6336
    s_waitcnt lgkmcnt(0)
    v_max3_f32 v104, v96, v98, v100
    v_max_f32 v104, v104, v102
    v_sub_f32 v96, v96, v104
    v_mul_f32 v96, s50, v96
    v_sub_f32 v98, v98, v104
    v_mul_f32 v98, s50, v98
    v_sub_f32 v100, v100, v104
    v_mul_f32 v100, s50, v100
    v_sub_f32 v102, v102, v104
    v_mul_f32 v102, s50, v102
    v_exp_f32 v96, v96
    v_exp_f32 v98, v98
    v_exp_f32 v100, v100
    v_exp_f32 v102, v102
    v_mul_f32 v105, v96, v97
    v_fmac_f32 v105, v98, v99
    v_fmac_f32 v105, v100, v101
    v_fmac_f32 v105, v102, v103
    v_bfi_b32 v104, v166, s80, v104
    v_bfi_b32 v105, v166, s81, v105
    v_bfi_b32 v106, v166, s82, v106
    v_bfi_b32 v107, v166, s83, v107
    buffer_store_dwordx4 v[104:107], v126, s[28:31], s47 offen sc1 nt
L_c_noml:
    s_mov_b64 exec, -1
    v_and_b32 v115, 7, v0
    v_mul_u32_u24 v115, 528, v115
    s_add_u32 s73, s46, 8192
    v_add3_u32 v115, v115, v125, s73
    v_and_b32 v117, 31, v0
    v_mul_u32_u24 v116, 528, v113
    v_lshl_add_u32 v116, v117, 4, v116
    v_add_u32 v116, 8192, v116
    v_add_u32 v118, 0x10000, v116
    v_lshrrev_b32 v119, 3, v117
    v_lshl_add_u32 v119, v113, 2, v119
    v_and_b32 v117, 7, v0
    v_lshlrev_b32 v117, 4, v117
    v_lshl_add_u32 v117, v119, 13, v117
    s_lshl_b32 s47, s64, 11
    s_add_u32 s47, s47, s65
    s_lshl_b32 s47, s47, 7
    s_add_u32 s47, s47, 1048576
    s_lshl_b32 s73, s76, 6
    s_add_u32 s74, s73, 137472
    v_add_u32 v108, s74, v125
    s_add_u32 s74, s73, 137728
    v_add_u32 v114, s74, v125
    v_lshrrev_b32 v113, 5, v0
    v_bfe_u32 v109, v0, 4, 1
    v_lshl_add_u32 v113, v109, 1, v113
    v_bfe_u32 v109, v0, 2, 1
    v_lshl_add_u32 v113, v109, 2, v113
    v_and_b32 v109, 3, v0
    v_lshl_add_u32 v113, v109, 3, v113
    v_lshl_add_u32 v113, v113, 1, s74
    v_lshrrev_b32 v109, 3, v0
    v_lshlrev_b32 v109, 5, v109
    v_add_u32 v109, 137984, v109
    s_lshl_b32 s73, s76, 9
    s_add_u32 s73, s73, 139264
    v_add_u32 v119, s73, v125
    s_lshl_b32 s44, s66, 2
    s_add_u32 s44, s44, s76
    s_lshl_b32 s44, s44, 13
    s_add_u32 s44, s44, 1048576
    s_add_u32 s45, s44, 4096
L_cloop:
    ds_read_b128 v[104:107], v127
    v_add_u32 v127, 512, v127
    s_cmp_eq_u32 s49, 19
    s_cbranch_scc1 L_c_last
Lsp_31:
    ds_read_b32 v3, v1 offset:0
    s_waitcnt lgkmcnt(0)
    v_readfirstlane_b32 s61, v3
    s_cmp_ge_i32 s61, s49
    s_cbranch_scc1 Lsp_32
    s_sub_u32 s60, s60, 1
    s_cbranch_scc0 Lsp_31
    s_mov_b32 s60, 0
Lsp_32:
    ds_read_b64_tr_b16 v[64:65], v8 offset:0
    ds_read_b64_tr_b16 v[66:67], v8 offset:4096
    ds_read_b64_tr_b16 v[68:69], v9 offset:0
    ds_read_b64_tr_b16 v[70:71], v9 offset:4096
    ds_read_b64_tr_b16 v[72:73], v10 offset:0
    ds_read_b64_tr_b16 v[74:75], v10 offset:4096
    ds_read_b64_tr_b16 v[76:77], v11 offset:0
    ds_read_b64_tr_b16 v[78:79], v11 offset:4096
    ds_read_b64_tr_b16 v[80:81], v12 offset:0
    ds_read_b64_tr_b16 v[82:83], v12 offset:4096
    ds_read_b64_tr_b16 v[84:85], v13 offset:0
    ds_read_b64_tr_b16 v[86:87], v13 offset:4096
    ds_read_b64_tr_b16 v[88:89], v14 offset:0
    ds_read_b64_tr_b16 v[90:91], v14 offset:4096
    s_waitcnt lgkmcnt(12)
    v_mfma_f32_16x16x32_bf16 v[32:35], v[64:67], v[104:107], v[32:35]
    ds_read_b64_tr_b16 v[92:93], v15 offset:0
    ds_read_b64_tr_b16 v[94:95], v15 offset:4096
    s_waitcnt lgkmcnt(12)
    v_mfma_f32_16x16x32_bf16 v[36:39], v[68:71], v[104:107], v[36:39]
    s_waitcnt lgkmcnt(10)
    v_mfma_f32_16x16x32_bf16 v[40:43], v[72:75], v[104:107], v[40:43]
    s_waitcnt lgkmcnt(8)
    v_mfma_f32_16x16x32_bf16 v[44:47], v[76:79], v[104:107], v[44:47]
    s_waitcnt lgkmcnt(6)
    v_mfma_f32_16x16x32_bf16 v[48:51], v[80:83], v[104:107], v[48:51]
    s_waitcnt lgkmcnt(4)
    v_mfma_f32_16x16x32_bf16 v[52:55], v[84:87], v[104:107], v[52:55]
    s_waitcnt lgkmcnt(2)
    v_mfma_f32_16x16x32_bf16 v[56:59], v[88:91], v[104:107], v[56:59]
    s_waitcnt lgkmcnt(0)
    v_mov_b32 v3, s49
    ds_write_b32 v1, v3 offset:1024
    v_mfma_f32_16x16x32_bf16 v[60:63], v[92:95], v[104:107], v[60:63]
    v_xor_b32 v8, s52, v8
    v_xor_b32 v9, s52, v9
    v_xor_b32 v10, s52, v10
    v_xor_b32 v11, s52, v11
    v_xor_b32 v12, s52, v12
    v_xor_b32 v13, s52, v13
    v_xor_b32 v14, s52, v14
    v_xor_b32 v15, s52, v15
    s_xor_b32 s52, s52, 0x4000
    s_add_u32 s49, s49, 1
    s_branch L_cloop
L_c_last:
Lsp_33:
    ds_read_b32 v3, v2 offset:2064
    ds_read_b128 v[16:19], v108
    s_waitcnt lgkmcnt(0)
    v_readfirstlane_b32 s61, v3
    s_cmp_ge_i32 s61, 1
    s_cbranch_scc1 Lsp_34
    s_sub_u32 s60, s60, 1
    s_cbranch_scc0 Lsp_33
    s_mov_b32 s60, 0
Lsp_34:
Lsp_35:
    ds_read_b32 v3, v2 offset:2068
    ds_read_b128 v[96:99], v109
    ds_read_b128 v[100:103], v109 offset:16
    s_waitcnt lgkmcnt(0)
    v_readfirstlane_b32 s61, v3
    s_cmp_ge_i32 s61, 1
    s_cbranch_scc1 Lsp_36
    s_sub_u32 s60, s60, 1
    s_cbranch_scc0 Lsp_35
    s_mov_b32 s60, 0
Lsp_36:
Lsp_37:
    ds_read_b32 v3, v1 offset:0
    s_waitcnt lgkmcnt(0)
    v_readfirstlane_b32 s61, v3
    s_cmp_ge_i32 s61, 19
    s_cbranch_scc1 Lsp_38
    s_sub_u32 s60, s60, 1
    s_cbranch_scc0 Lsp_37
    s_mov_b32 s60, 0
Lsp_38:
    ds_read_b64_tr_b16 v[64:65], v8 offset:0
    ds_read_b64_tr_b16 v[66:67], v8 offset:4096
    ds_read_b64_tr_b16 v[68:69], v9 offset:0
    ds_read_b64_tr_b16 v[70:71], v9 offset:4096
    ds_read_b64_tr_b16 v[72:73], v10 offset:0
    ds_read_b64_tr_b16 v[74:75], v10 offset:4096
    ds_read_b64_tr_b16 v[76:77], v11 offset:0
    ds_read_b64_tr_b16 v[78:79], v11 offset:4096
    ds_read_b64_tr_b16 v[80:81], v12 offset:0
    ds_read_b64_tr_b16 v[82:83], v12 offset:4096
    ds_read_b64_tr_b16 v[84:85], v13 offset:0
    ds_read_b64_tr_b16 v[86:87], v13 offset:4096
    ds_read_b64_tr_b16 v[88:89], v14 offset:0
    ds_read_b64_tr_b16 v[90:91], v14 offset:4096
    s_waitcnt lgkmcnt(12)
    v_mfma_f32_16x16x32_bf16 v[32:35], v[64:67], v[104:107], v[32:35]
    ds_read_b64_tr_b16 v[92:93], v15 offset:0
    ds_read_b64_tr_b16 v[94:95], v15 offset:4096
    s_waitcnt lgkmcnt(12)
    v_mfma_f32_16x16x32_bf16 v[36:39], v[68:71], v[104:107], v[36:39]
    s_waitcnt lgkmcnt(10)
    v_mfma_f32_16x16x32_bf16 v[40:43], v[72:75], v[104:107], v[40:43]
    s_waitcnt lgkmcnt(8)
    v_mfma_f32_16x16x32_bf16 v[44:47], v[76:79], v[104:107], v[44:47]
    s_waitcnt lgkmcnt(6)
    v_mfma_f32_16x16x32_bf16 v[48:51], v[80:83], v[104:107], v[48:51]
    ds_write_b128 v115, v[32:35] offset:0
    s_waitcnt lgkmcnt(5)
    v_mfma_f32_16x16x32_bf16 v[52:55], v[84:87], v[104:107], v[52:55]
    ds_write_b128 v115, v[36:39] offset:64
    s_waitcnt lgkmcnt(4)
    v_mfma_f32_16x16x32_bf16 v[56:59], v[88:91], v[104:107], v[56:59]
    ds_write_b128 v115, v[40:43] offset:128
    s_waitcnt lgkmcnt(3)
    v_mfma_f32_16x16x32_bf16 v[60:63], v[92:95], v[104:107], v[60:63]
    ds_write_b128 v115, v[44:47] offset:192
    ds_write_b128 v115, v[48:51] offset:256
    ds_write_b128 v115, v[52:55] offset:320
    s_nop 1
    ds_write_b128 v115, v[56:59] offset:384
    s_nop 1
    ds_write_b128 v115, v[60:63] offset:448
    s_mov_b64 exec, 1
    ds_add_u32 v2, v124 offset:2076
    s_mov_b64 exec, -1
Lsp_39:
    ds_read_b32 v3, v2 offset:2076
    ds_read_b128 v[64:67], v116
    ds_read_b128 v[68:71], v116 offset:32768
    ds_read_b128 v[72:75], v118
    ds_read_b128 v[76:79], v118 offset:32768
    s_waitcnt lgkmcnt(0)
    v_readfirstlane_b32 s61, v3
    s_cmp_ge_i32 s61, 4
    s_cbranch_scc1 Lsp_40
    s_sub_u32 s60, s60, 1
    s_cbranch_scc0 Lsp_39
    s_mov_b32 s60, 0
Lsp_40:
    v_pk_mul_f32 v[64:65], v[64:65], v[160:161] op_sel_hi:[1,0]
    v_pk_mul_f32 v[66:67], v[66:67], v[160:161] op_sel_hi:[1,0]
    v_pk_fma_f32 v[64:65], v[68:69], v[160:161], v[64:65] op_sel:[0,1,0] op_sel_hi:[1,1,1]
    v_pk_fma_f32 v[66:67], v[70:71], v[160:161], v[66:67] op_sel:[0,1,0] op_sel_hi:[1,1,1]
    v_pk_fma_f32 v[64:65], v[72:73], v[162:163], v[64:65] op_sel_hi:[1,0,1]
    v_pk_fma_f32 v[66:67], v[74:75], v[162:163], v[66:67] op_sel_hi:[1,0,1]
    v_pk_fma_f32 v[64:65], v[76:77], v[162:163], v[64:65] op_sel:[0,1,0] op_sel_hi:[1,1,1]
    v_pk_fma_f32 v[66:67], v[78:79], v[162:163], v[66:67] op_sel:[0,1,0] op_sel_hi:[1,1,1]
    v_bfi_b32 v64, v166, s80, v64
    v_bfi_b32 v65, v166, s81, v65
    v_bfi_b32 v66, v166, s82, v66
    v_bfi_b32 v67, v166, s83, v67
    buffer_store_dwordx4 v[64:67], v117, s[28:31], s47 offen sc1
Lsp_41:
    ds_read_b32 v3, v1 offset:0
    s_waitcnt lgkmcnt(0)
    v_readfirstlane_b32 s61, v3
    s_cmp_ge_i32 s61, 20
    s_cbranch_scc1 Lsp_42
    s_sub_u32 s60, s60, 1
    s_cbranch_scc0 Lsp_41
    s_mov_b32 s60, 0
Lsp_42:
    ds_read_b64_tr_b16 v[64:65], v8 offset:8192
    ds_read_b64_tr_b16 v[66:67], v8 offset:12288
    ds_read_b64_tr_b16 v[68:69], v9 offset:8192
    ds_read_b64_tr_b16 v[70:71], v9 offset:12288
    ds_read_b64_tr_b16 v[72:73], v10 offset:8192
    ds_read_b64_tr_b16 v[74:75], v10 offset:12288
    ds_read_b64_tr_b16 v[76:77], v11 offset:8192
    ds_read_b64_tr_b16 v[78:79], v11 offset:12288
    ds_read_b64_tr_b16 v[80:81], v12 offset:8192
    ds_read_b64_tr_b16 v[82:83], v12 offset:12288
    ds_read_b64_tr_b16 v[84:85], v13 offset:8192
    ds_read_b64_tr_b16 v[86:87], v13 offset:12288
    ds_read_b64_tr_b16 v[88:89], v14 offset:8192
    ds_read_b64_tr_b16 v[90:91], v14 offset:12288
    s_waitcnt lgkmcnt(12)
    v_mfma_f32_16x16x32_bf16 v[32:35], v[64:67], v[16:19], 0
    ds_read_b64_tr_b16 v[92:93], v15 offset:8192
    ds_read_b64_tr_b16 v[94:95], v15 offset:12288
    s_waitcnt lgkmcnt(12)
    v_mfma_f32_16x16x32_bf16 v[36:39], v[68:71], v[16:19], 0
    s_waitcnt lgkmcnt(10)
    v_mfma_f32_16x16x32_bf16 v[40:43], v[72:75], v[16:19], 0
    s_waitcnt lgkmcnt(8)
    v_mfma_f32_16x16x32_bf16 v[44:47], v[76:79], v[16:19], 0
    s_waitcnt lgkmcnt(6)
    v_mfma_f32_16x16x32_bf16 v[48:51], v[80:83], v[16:19], 0
    s_mov_b32 exec_lo, 0x10001
    s_mov_b32 exec_hi, 0x10001
    ds_write_b128 v119, v[32:35] offset:0
    s_waitcnt lgkmcnt(5)
    v_mfma_f32_16x16x32_bf16 v[52:55], v[84:87], v[16:19], 0
    ds_write_b128 v119, v[36:39] offset:64
    s_waitcnt lgkmcnt(4)
    v_mfma_f32_16x16x32_bf16 v[56:59], v[88:91], v[16:19], 0
    ds_write_b128 v119, v[40:43] offset:128
    s_waitcnt lgkmcnt(3)
    v_mfma_f32_16x16x32_bf16 v[60:63], v[92:95], v[16:19], 0
    ds_write_b128 v119, v[44:47] offset:192
    ds_write_b128 v119, v[48:51] offset:256
    ds_write_b128 v119, v[52:55] offset:320
    s_nop 1
    ds_write_b128 v119, v[56:59] offset:384
    s_nop 1
    ds_write_b128 v119, v[60:63] offset:448
    s_mov_b64 exec, 1
    ds_add_u32 v2, v124 offset:2080
    s_mov_b64 exec, -1
    v_xor_b32 v8, 0x4000, v8
    v_xor_b32 v9, 0x4000, v9
    v_xor_b32 v10, 0x4000, v10
    v_xor_b32 v11, 0x4000, v11
    v_xor_b32 v12, 0x4000, v12
    v_xor_b32 v13, 0x4000, v13
    v_xor_b32 v14, 0x4000, v14
    v_xor_b32 v15, 0x4000, v15
Lsp_43:
    ds_read_b32 v3, v1 offset:0
    s_waitcnt lgkmcnt(0)
    v_readfirstlane_b32 s61, v3
    s_cmp_ge_i32 s61, 21
    s_cbranch_scc1 Lsp_44
    s_sub_u32 s60, s60, 1
    s_cbranch_scc0 Lsp_43
    s_mov_b32 s60, 0
Lsp_44:
    buffer_load_dwordx4 v[128:131], v126, s[28:31], s44 offen offset:0 sc1
    buffer_load_dwordx4 v[132:135], v126, s[28:31], s44 offen offset:1024 sc1
    buffer_load_dwordx4 v[136:139], v126, s[28:31], s44 offen offset:2048 sc1
    buffer_load_dwordx4 v[140:143], v126, s[28:31], s44 offen offset:3072 sc1
    buffer_load_dwordx4 v[144:147], v126, s[28:31], s45 offen offset:0 sc1
    buffer_load_dwordx4 v[148:151], v126, s[28:31], s45 offen offset:1024 sc1
    buffer_load_dwordx4 v[152:155], v126, s[28:31], s45 offen offset:2048 sc1
    buffer_load_dwordx4 v[156:159], v126, s[28:31], s45 offen offset:3072 sc1
    ds_read_b64_tr_b16 v[64:65], v8
    ds_read_b64_tr_b16 v[66:67], v8 offset:4096
    ds_read_b64_tr_b16 v[68:69], v9
    ds_read_b64_tr_b16 v[70:71], v9 offset:4096
    ds_read_b64_tr_b16 v[72:73], v10
    ds_read_b64_tr_b16 v[74:75], v10 offset:4096
    ds_read_b64_tr_b16 v[76:77], v11
    ds_read_b64_tr_b16 v[78:79], v11 offset:4096
    ds_read_b64_tr_b16 v[80:81], v12
    ds_read_b64_tr_b16 v[82:83], v12 offset:4096
    ds_read_b64_tr_b16 v[84:85], v13
    ds_read_b64_tr_b16 v[86:87], v13 offset:4096
    ds_read_b64_tr_b16 v[88:89], v14
    ds_read_b64_tr_b16 v[90:91], v14 offset:4096
    s_waitcnt lgkmcnt(4)
    ds_read_b64_tr_b16 v[92:93], v15
    ds_read_b64_tr_b16 v[94:95], v15 offset:4096
    s_branch Lpl_47
Lpl_45:
    buffer_load_dwordx4 v[128:131], v126, s[28:31], s44 offen offset:0 sc1
    buffer_load_dwordx4 v[132:135], v126, s[28:31], s44 offen offset:1024 sc1
    buffer_load_dwordx4 v[136:139], v126, s[28:31], s44 offen offset:2048 sc1
    buffer_load_dwordx4 v[140:143], v126, s[28:31], s44 offen offset:3072 sc1
    buffer_load_dwordx4 v[144:147], v126, s[28:31], s45 offen offset:0 sc1
    buffer_load_dwordx4 v[148:151], v126, s[28:31], s45 offen offset:1024 sc1
    buffer_load_dwordx4 v[152:155], v126, s[28:31], s45 offen offset:2048 sc1
    buffer_load_dwordx4 v[156:159], v126, s[28:31], s45 offen offset:3072 sc1
Lpl_47:
    s_waitcnt vmcnt(0)
    v_xor_b32 v128, s80, v128
    v_xor_b32 v129, s81, v129
    v_xor_b32 v130, s82, v130
    v_xor_b32 v131, s83, v131
    v_xor_b32 v132, s80, v132
    v_xor_b32 v133, s81, v133
    v_xor_b32 v134, s82, v134
    v_xor_b32 v135, s83, v135
    v_xor_b32 v136, s80, v136
    v_xor_b32 v137, s81, v137
    v_xor_b32 v138, s82, v138
    v_xor_b32 v139, s83, v139
    v_xor_b32 v140, s80, v140
    v_xor_b32 v141, s81, v141
    v_xor_b32 v142, s82, v142
    v_xor_b32 v143, s83, v143
    v_xor_b32 v144, s80, v144
    v_xor_b32 v145, s81, v145
    v_xor_b32 v146, s82, v146
    v_xor_b32 v147, s83, v147
    v_xor_b32 v148, s80, v148
    v_xor_b32 v149, s81, v149
    v_xor_b32 v150, s82, v150
    v_xor_b32 v151, s83, v151
    v_xor_b32 v152, s80, v152
    v_xor_b32 v153, s81, v153
    v_xor_b32 v154, s82, v154
    v_xor_b32 v155, s83, v155
    v_xor_b32 v156, s80, v156
    v_xor_b32 v157, s81, v157
    v_xor_b32 v158, s82, v158
    v_xor_b32 v159, s83, v159
    v_or3_b32 v110, v128, v129, v130
    v_or3_b32 v110, v110, v131, v132
    v_or3_b32 v110, v110, v133, v134
    v_or3_b32 v110, v110, v135, v136
    v_or3_b32 v110, v110, v137, v138
    v_or3_b32 v110, v110, v139, v140
    v_or3_b32 v110, v110, v141, v142
    v_or3_b32 v110, v110, v143, v144
    v_or3_b32 v110, v110, v145, v146
    v_or3_b32 v110, v110, v147, v148
    v_or3_b32 v110, v110, v149, v150
    v_or3_b32 v110, v110, v151, v152
    v_or3_b32 v110, v110, v153, v154
    v_or3_b32 v110, v110, v155, v156
    v_or3_b32 v110, v110, v157, v158
    v_or_b32 v110, v110, v159
    v_and_b32 v110, 0x3ff, v110
    v_cmp_ne_u32 vcc, 0, v110
    s_cbranch_vccz Lpl_46
    s_mov_b64 exec, vcc
    s_sub_u32 s60, s60, 16
    s_cbranch_scc0 Lpl_45
    s_mov_b32 s60, 0
Lpl_46:
    s_mov_b64 exec, -1
    v_pk_mul_f32 v[128:129], v[128:129], v[96:97] op_sel_hi:[1,0]
    v_pk_mul_f32 v[130:131], v[130:131], v[96:97] op_sel_hi:[1,0]
    v_pk_fma_f32 v[128:129], v[132:133], v[96:97], v[128:129] op_sel:[0,1,0] op_sel_hi:[1,1,1]
    v_pk_fma_f32 v[130:131], v[134:135], v[96:97], v[130:131] op_sel:[0,1,0] op_sel_hi:[1,1,1]
    v_pk_fma_f32 v[128:129], v[136:137], v[98:99], v[128:129] op_sel_hi:[1,0,1]
    v_pk_fma_f32 v[130:131], v[138:139], v[98:99], v[130:131] op_sel_hi:[1,0,1]
    v_pk_fma_f32 v[128:129], v[140:141], v[98:99], v[128:129] op_sel:[0,1,0] op_sel_hi:[1,1,1]
    v_pk_fma_f32 v[130:131], v[142:143], v[98:99], v[130:131] op_sel:[0,1,0] op_sel_hi:[1,1,1]
    v_pk_fma_f32 v[128:129], v[144:145], v[100:101], v[128:129] op_sel_hi:[1,0,1]
    v_pk_fma_f32 v[130:131], v[146:147], v[100:101], v[130:131] op_sel_hi:[1,0,1]
    v_pk_fma_f32 v[128:129], v[148:149], v[100:101], v[128:129] op_sel:[0,1,0] op_sel_hi:[1,1,1]
    v_pk_fma_f32 v[130:131], v[150:151], v[100:101], v[130:131] op_sel:[0,1,0] op_sel_hi:[1,1,1]
    v_pk_fma_f32 v[128:129], v[152:153], v[102:103], v[128:129] op_sel_hi:[1,0,1]
    v_pk_fma_f32 v[130:131], v[154:155], v[102:103], v[130:131] op_sel_hi:[1,0,1]
    v_pk_fma_f32 v[128:129], v[156:157], v[102:103], v[128:129] op_sel:[0,1,0] op_sel_hi:[1,1,1]
    v_pk_fma_f32 v[130:131], v[158:159], v[102:103], v[130:131] op_sel:[0,1,0] op_sel_hi:[1,1,1]
    s_nop 0
    v_permlane32_swap_b32 v128, v129
    v_permlane32_swap_b32 v130, v131
    v_add_f32 v128, v128, v129
    v_add_f32 v130, v130, v131
    s_nop 1
    v_permlane16_swap_b32 v128, v130
    v_add_f32 v128, v128, v130
    s_nop 1
    v_add_f32_dpp v128, v128, v128 row_ror:8 row_mask:0xf bank_mask:0xf
    v_cvt_pk_bf16_f32 v128, v128, v128
    ds_write_b16 v113, v128
    ds_read_b128 v[104:107], v114
    s_mov_b32 exec_lo, 0x10001
    s_mov_b32 exec_hi, 0x10001
    s_waitcnt lgkmcnt(0)
    v_mfma_f32_16x16x32_bf16 v[32:35], v[64:67], v[104:107], 0
    v_mfma_f32_16x16x32_bf16 v[36:39], v[68:71], v[104:107], 0
    v_mfma_f32_16x16x32_bf16 v[40:43], v[72:75], v[104:107], 0
    v_mfma_f32_16x16x32_bf16 v[44:47], v[76:79], v[104:107], 0
    v_mfma_f32_16x16x32_bf16 v[48:51], v[80:83], v[104:107], 0
    s_nop 3
    ds_write_b128 v119, v[32:35] offset:2048
    v_mfma_f32_16x16x32_bf16 v[52:55], v[84:87], v[104:107], 0
    ds_write_b128 v119, v[36:39] offset:2112
    v_mfma_f32_16x16x32_bf16 v[56:59], v[88:91], v[104:107], 0
    ds_write_b128 v119, v[40:43] offset:2176
    v_mfma_f32_16x16x32_bf16 v[60:63], v[92:95], v[104:107], 0
    ds_write_b128 v119, v[44:47] offset:2240
    ds_write_b128 v119, v[48:51] offset:2304
    s_nop 1
    ds_write_b128 v119, v[52:55] offset:2368
    s_nop 0
    ds_write_b128 v119, v[56:59] offset:2432
    s_nop 0
    ds_write_b128 v119, v[60:63] offset:2496
    s_mov_b64 exec, 1
    ds_add_u32 v2, v124 offset:2084
    s_endpgm
L_P:
    s_barrier
    s_lshl_b32 s66, s64, 3
    s_and_b32 s73, s2, 7
    s_or_b32 s66, s66, s73
    s_bfe_u32 s67, s2, 0x30003
    s_bfe_u32 s70, s2, 0x40003
    s_mov_b32 s28, s26
    s_mov_b32 s29, s27
    s_mov_b32 s30, 268435456
    s_mov_b32 s31, 0x20000
    s_mov_b32 s40, s22
    s_mov_b32 s41, s23
    s_mov_b32 s42, 2048
    s_mov_b32 s43, 0x20000
    v_lshlrev_b32 v1, 4, v0
    v_mov_b32 v2, 131072
    v_mov_b32 v4, 0
    v_mov_b32 v5, 0x3ff
    v_mov_b32 v10, 1
    v_lshrrev_b32 v8, 5, v0
    v_bfe_u32 v9, v0, 4, 1
    v_lshl_add_u32 v8, v9, 1, v8
    v_lshlrev_b32 v8, 1, v8
    s_and_b32 s44, s2, 7
    s_lshl_b32 s44, s44, 5
    s_lshr_b32 s73, s2, 3
    s_or_b32 s44, s44, s73
    s_lshl_b32 s51, s44, 4
    s_lshl_b32 s44, s44, 3
    s_lshl_b32 s47, s64, 4
    s_add_u32 s47, s47, s68
    s_lshl_b32 s47, s47, 4
    s_add_u32 s47, s47, s69
    s_lshl_b32 s47, s47, 7
    v_lshrrev_b32 v14, 3, v0
    v_and_b32 v12, 7, v0
    v_lshlrev_b32 v6, 4, v12
    v_lshl_or_b32 v7, v14, 11, v6
    v_lshl_or_b32 v6, v14, 9, v6
    v_lshlrev_b32 v15, 3, v0
    v_add_u32 v13, 134144, v15
    v_mul_u32_u24 v11, 7, v14
    v_add_u32 v11, v11, v12
    v_lshlrev_b32 v11, 4, v11
    v_add_u32 v11, 139264, v11
    s_lshl_b32 s48, s70, 7
    s_lshl_b32 s73, s72, 3
    s_add_u32 s48, s48, s73
    s_add_u32 s48, s48, s71
    s_lshl_b32 s48, s48, 7
    s_add_u32 s48, s48, 131072
    s_mov_b32 exec_lo, 0xffffffff
    s_mov_b32 exec_hi, 0x0
Lsp_48:
    ds_read_b32 v3, v2 offset:2048
    s_waitcnt lgkmcnt(0)
    v_readfirstlane_b32 s61, v3
    s_cmp_ge_i32 s61, 1
    s_cbranch_scc1 Lsp_49
    s_sub_u32 s60, s60, 1
    s_cbranch_scc0 Lsp_48
    s_mov_b32 s60, 0
Lsp_49:
    s_mul_i32 s84, s79, 0x9e3779b1
    s_add_u32 s84, s84, 0x7f4a7c15
    s_and_b32 s80, s84, 0x3ff
    s_add_u32 s81, s80, 256
    s_and_b32 s81, s81, 0x3ff
    s_add_u32 s82, s80, 512
    s_and_b32 s82, s82, 0x3ff
    s_add_u32 s83, s80, 768
    s_and_b32 s83, s83, 0x3ff
    v_mov_b32 v25, s84
    v_mov_b32 v27, s84
Lsp_50:
    ds_read_b32 v3, v2 offset:2048
    ds_read_b64 v[16:17], v13 offset:0
    ds_read_b64 v[18:19], v13 offset:256
    ds_read_b64 v[20:21], v13 offset:512
    ds_read_b64 v[22:23], v13 offset:768
    s_waitcnt lgkmcnt(0)
    v_readfirstlane_b32 s61, v3
    s_cmp_ge_i32 s61, 4
    s_cbranch_scc1 Lsp_51
    s_sub_u32 s60, s60, 1
    s_cbranch_scc0 Lsp_50
    s_mov_b32 s60, 0
Lsp_51:
    v_pk_add_f32 v[16:17], v[16:17], v[18:19]
    v_pk_add_f32 v[20:21], v[20:21], v[22:23]
    v_add_f32 v24, v16, v20
    v_add_f32 v26, v17, v21
    buffer_store_dwordx4 v[24:27], v6, s[28:31], s47 offen offset:0 sc1 nt
    s_mov_b64 exec, -1
    buffer_load_ushort v9, v8, s[32:35], s44 offen
Lsp_52:
    ds_read_b32 v3, v2 offset:2052
    s_waitcnt lgkmcnt(0)
    v_readfirstlane_b32 s61, v3
    s_cmp_ge_i32 s61, 4
    s_cbranch_scc1 Lsp_53
    s_sub_u32 s60, s60, 1
    s_cbranch_scc0 Lsp_52
    s_mov_b32 s60, 0
Lsp_53:
    ds_read_b128 v[16:19], v11 offset:0
    ds_read_b128 v[20:23], v11 offset:896
    ds_read_b128 v[24:27], v11 offset:1792
    ds_read_b128 v[28:31], v11 offset:2688
    s_waitcnt lgkmcnt(0)
    v_pk_add_f32 v[16:17], v[16:17], v[20:21]
    v_pk_add_f32 v[24:25], v[24:25], v[28:29]
    v_pk_add_f32 v[18:19], v[18:19], v[22:23]
    v_pk_add_f32 v[26:27], v[26:27], v[30:31]
    v_pk_add_f32 v[16:17], v[16:17], v[24:25]
    v_pk_add_f32 v[18:19], v[18:19], v[26:27]
    v_add_u32 v16, 512, v16
    v_add_u32 v17, 512, v17
    v_add_u32 v18, 512, v18
    v_add_u32 v19, 512, v19
    v_bfi_b32 v16, v5, s80, v16
    v_bfi_b32 v17, v5, s81, v17
    v_bfi_b32 v18, v5, s82, v18
    v_bfi_b32 v19, v5, s83, v19
    buffer_store_dwordx4 v[16:19], v7, s[28:31], s48 offen sc1 nt
    s_lshl_b32 s47, s2, 9
    s_lshl_b32 s49, s2, 6
    s_add_u32 s49, s49, 458752
    s_mov_b32 exec_lo, 0xffffffff
    s_mov_b32 exec_hi, 0x0
Lsp_54:
    ds_read_b32 v3, v2 offset:0
    s_waitcnt lgkmcnt(0)
    v_readfirstlane_b32 s61, v3
    s_cmp_ge_i32 s61, 4
    s_cbranch_scc1 Lsp_55
    s_sub_u32 s60, s60, 1
    s_cbranch_scc0 Lsp_54
    s_mov_b32 s60, 0
Lsp_55:
Lpl_56:
    buffer_load_dwordx4 v[16:19], v1, s[28:31], s47 offen offset:0 sc1 nt
Lpl_58:
    s_waitcnt vmcnt(0)
    v_xor_b32 v17, s84, v17
    v_xor_b32 v19, s84, v19
    v_or_b32 v20, v17, v19
    v_cmp_ne_u32 vcc, 0, v20
    s_cbranch_vccz Lpl_57
    s_mov_b64 exec, vcc
    s_sleep 6
    s_sub_u32 s60, s60, 16
    s_cbranch_scc0 Lpl_56
    s_mov_b32 s60, 0
Lpl_57:
    s_mov_b64 exec, -1
    v_add_f32_dpp v16, v16, v16 row_ror:8 row_mask:0xf bank_mask:0xf
    v_add_f32_dpp v18, v18, v18 row_ror:8 row_mask:0xf bank_mask:0xf
    v_mov_b32 v17, v16
    v_mov_b32 v19, v18
    s_nop 0
    v_permlane16_swap_b32 v16, v17
    v_permlane16_swap_b32 v18, v19
    v_add_f32 v16, v16, v17
    v_add_f32 v18, v18, v19
    v_cvt_pk_bf16_f32 v16, v16, v18
    v_mov_b32 v17, s84
    s_mov_b32 exec_lo, 0xff
    s_mov_b32 exec_hi, 0x0
    buffer_store_dwordx2 v[16:17], v15, s[28:31], s49 offen sc1 nt
    s_mov_b64 exec, -1
    s_lshl_b32 s47, s64, 12
    s_add_u32 s47, s47, 458752
    v_add_u32 v13, 135168, v15
    s_and_b32 s54, s2, 7
    s_lshl_b32 s54, s54, 8
    s_add_u32 s54, s54, 430080
    s_lshr_b32 s55, s2, 3
    s_lshl_b32 s55, s55, 2
    s_add_u32 s55, s55, s54
    v_lshlrev_b32 v36, 2, v0
    s_lshl_b32 s48, s84, 8
    s_mov_b32 exec_lo, 0xffffffff
    s_mov_b32 exec_hi, 0x0
Lsp_59:
    ds_read_b32 v3, v2 offset:0
    s_waitcnt lgkmcnt(0)
    v_readfirstlane_b32 s61, v3
    s_cmp_ge_i32 s61, 6
    s_cbranch_scc1 Lsp_60
    s_sub_u32 s60, s60, 1
    s_cbranch_scc0 Lsp_59
    s_mov_b32 s60, 0
Lsp_60:
    buffer_load_dword v37, v36, s[28:31], s54 offen sc1
    s_add_u32 s56, s48, 6
    v_mov_b32 v38, s56
    s_mov_b64 exec, 1
    buffer_store_dword v38, v4, s[28:31], s55 offen
    s_mov_b32 exec_lo, -1
    s_waitcnt vmcnt(1)
    v_subrev_u32 v37, s56, v37
    v_cmp_gt_u32 vcc, 32, v37
    s_bcnt1_i32_b32 s61, vcc_lo
    s_cmp_lt_u32 s61, 12
    s_cselect_b32 s56, 1, 0
    s_cmp_ge_u32 s61, 26
    s_cselect_b32 s56, 2, s56
    v_mov_b32 v37, s56
    ds_write_b32 v2, v37 offset:2088
    s_mov_b64 exec, -1
Lsp_61:
    ds_read_b32 v3, v2 offset:0
    s_waitcnt lgkmcnt(0)
    v_readfirstlane_b32 s61, v3
    s_cmp_ge_i32 s61, 7
    s_cbranch_scc1 Lsp_62
    s_sub_u32 s60, s60, 1
    s_cbranch_scc0 Lsp_61
    s_mov_b32 s60, 0
Lsp_62:
Lpl_63:
    buffer_load_dwordx4 v[16:19], v1, s[28:31], s47 offen offset:0 sc1
    buffer_load_dwordx4 v[20:23], v1, s[28:31], s47 offen offset:1024 sc1
    buffer_load_dwordx4 v[24:27], v1, s[28:31], s47 offen offset:2048 sc1
    buffer_load_dwordx4 v[28:31], v1, s[28:31], s47 offen offset:3072 sc1
Lpl_65:
    s_waitcnt vmcnt(0)
    v_xor_b32 v17, s84, v17
    v_xor_b32 v19, s84, v19
    v_xor_b32 v21, s84, v21
    v_xor_b32 v23, s84, v23
    v_xor_b32 v25, s84, v25
    v_xor_b32 v27, s84, v27
    v_xor_b32 v29, s84, v29
    v_xor_b32 v31, s84, v31
    v_or3_b32 v32, v17, v19, v21
    v_or3_b32 v32, v32, v23, v25
    v_or3_b32 v32, v32, v27, v29
    v_or_b32 v32, v32, v31
    v_cmp_ne_u32 vcc, 0, v32
    s_cbranch_vccz Lpl_64
    s_mov_b64 exec, vcc
    s_sleep 6
    s_sub_u32 s60, s60, 16
    s_cbranch_scc0 Lpl_63
    s_mov_b32 s60, 0
Lpl_64:
    s_mov_b64 exec, -1
    v_mov_b32 v17, v18
    ds_write_b64 v13, v[16:17] offset:0
    v_mov_b32 v21, v22
    ds_write_b64 v13, v[20:21] offset:512
    v_mov_b32 v25, v26
    ds_write_b64 v13, v[24:25] offset:1024
    v_mov_b32 v29, v30
    ds_write_b64 v13, v[28:29] offset:1536
    ds_write_b32 v2, v10 offset:2056
    s_mov_b32 exec_lo, 0xffffffff
    s_mov_b32 exec_hi, 0x0
Lsp_66:
    ds_read_b32 v3, v2 offset:0
    s_waitcnt lgkmcnt(0)
    v_readfirstlane_b32 s61, v3
    s_cmp_ge_i32 s61, 8
    s_cbranch_scc1 Lsp_67
    s_sub_u32 s60, s60, 1
    s_cbranch_scc0 Lsp_66
    s_mov_b32 s60, 0
Lsp_67:
    buffer_load_dword v37, v36, s[28:31], s54 offen sc1
    s_add_u32 s56, s48, 8
    v_mov_b32 v38, s56
    s_mov_b64 exec, 1
    buffer_store_dword v38, v4, s[28:31], s55 offen
    s_mov_b32 exec_lo, -1
    s_waitcnt vmcnt(1)
    v_subrev_u32 v37, s56, v37
    v_cmp_gt_u32 vcc, 32, v37
    s_bcnt1_i32_b32 s61, vcc_lo
    s_cmp_lt_u32 s61, 12
    s_cselect_b32 s56, 1, 0
    s_cmp_ge_u32 s61, 26
    s_cselect_b32 s56, 2, s56
    v_mov_b32 v37, s56
    ds_write_b32 v2, v37 offset:2088
    s_mov_b64 exec, -1
    s_lshl_b32 s45, s66, 2
    s_add_u32 s46, s45, s67
    s_lshl_b32 s45, s45, 7
    s_add_u32 s45, s45, 442368
    s_cmp_ge_u32 s67, 4
    s_cbranch_scc1 L_p_noh
    s_lshl_b32 s47, s46, 11
    s_add_u32 s47, s47, 131072
    s_lshl_b32 s46, s46, 7
    s_add_u32 s46, s46, 442368
Lsp_68:
    ds_read_b32 v3, v2 offset:0
    s_waitcnt lgkmcnt(0)
    v_readfirstlane_b32 s61, v3
    s_cmp_ge_i32 s61, 9
    s_cbranch_scc1 Lsp_69
    s_sub_u32 s60, s60, 1
    s_cbranch_scc0 Lsp_68
    s_mov_b32 s60, 0
Lsp_69:
Lpl_70:
    buffer_load_dwordx4 v[16:19], v1, s[28:31], s47 offen sc1 nt
    buffer_load_dwordx4 v[20:23], v1, s[28:31], s47 offen offset:1024 sc1 nt
Lpl_72:
    s_waitcnt vmcnt(0)
    v_xor_b32 v16, s80, v16
    v_xor_b32 v17, s81, v17
    v_xor_b32 v18, s82, v18
    v_xor_b32 v19, s83, v19
    v_xor_b32 v20, s80, v20
    v_xor_b32 v21, s81, v21
    v_xor_b32 v22, s82, v22
    v_xor_b32 v23, s83, v23
    v_or3_b32 v24, v16, v17, v18
    v_or3_b32 v24, v24, v19, v20
    v_or3_b32 v24, v24, v21, v22
    v_or_b32 v24, v24, v23
    v_and_b32 v24, 0x3ff, v24
    v_cmp_ne_u32 vcc, 0, v24
    s_cbranch_vccz Lpl_71
    s_mov_b64 exec, vcc
    s_sleep 16
    s_sub_u32 s60, s60, 16
    s_cbranch_scc0 Lpl_70
    s_mov_b32 s60, 0
Lpl_71:
    s_mov_b64 exec, -1
    v_permlane32_swap_b32 v16, v20
    v_permlane32_swap_b32 v17, v21
    v_permlane32_swap_b32 v18, v22
    v_permlane32_swap_b32 v19, v23
    v_add_f32 v16, v16, v20
    v_add_f32 v17, v17, v21
    v_add_f32 v18, v18, v22
    v_add_f32 v19, v19, v23
    v_add_f32_dpp v16, v16, v16 row_ror:8 row_mask:0xf bank_mask:0xf
    v_add_f32_dpp v17, v17, v17 row_ror:8 row_mask:0xf bank_mask:0xf
    v_add_f32_dpp v18, v18, v18 row_ror:8 row_mask:0xf bank_mask:0xf
    v_add_f32_dpp v19, v19, v19 row_ror:8 row_mask:0xf bank_mask:0xf
    v_mov_b32 v20, v16
    v_mov_b32 v21, v17
    v_mov_b32 v22, v18
    v_mov_b32 v23, v19
    v_permlane16_swap_b32 v16, v20
    v_permlane16_swap_b32 v17, v21
    v_permlane16_swap_b32 v18, v22
    v_permlane16_swap_b32 v19, v23
    v_add_f32 v16, v16, v20
    v_add_f32 v17, v17, v21
    v_add_f32 v18, v18, v22
    v_add_f32 v19, v19, v23
    v_cvt_pk_bf16_f32 v16, v16, v16
    v_cvt_pk_bf16_f32 v17, v17, v17
    v_cvt_pk_bf16_f32 v18, v18, v18
    v_cvt_pk_bf16_f32 v19, v19, v19
    v_and_b32 v16, 0xffff0000, v16
    v_and_b32 v17, 0xffff0000, v17
    v_and_b32 v18, 0xffff0000, v18
    v_and_b32 v19, 0xffff0000, v19
    v_mov_b32 v20, v16
    v_mov_b32 v21, v17
    v_mov_b32 v22, v18
    v_mov_b32 v23, v19
    v_permlane32_swap_b32 v16, v20
    v_permlane32_swap_b32 v17, v21
    v_permlane32_swap_b32 v18, v22
    v_permlane32_swap_b32 v19, v23
    v_mul_f32 v24, 0xbfb8aa3b, v16
    v_mul_f32 v25, 0xbfb8aa3b, v17
    v_mul_f32 v26, 0xbfb8aa3b, v18
    v_mul_f32 v27, 0xbfb8aa3b, v19
    v_exp_f32 v24, v24
    v_exp_f32 v25, v25
    v_exp_f32 v26, v26
    v_exp_f32 v27, v27
    v_add_f32 v24, 1.0, v24
    v_add_f32 v25, 1.0, v25
    v_add_f32 v26, 1.0, v26
    v_add_f32 v27, 1.0, v27
    v_rcp_f32 v24, v24
    v_rcp_f32 v25, v25
    v_rcp_f32 v26, v26
    v_rcp_f32 v27, v27
    v_mul_f32 v16, v16, v24
    v_mul_f32 v17, v17, v25
    v_mul_f32 v18, v18, v26
    v_mul_f32 v19, v19, v27
    v_cvt_pk_bf16_f32 v16, v16, v16
    v_cvt_pk_bf16_f32 v17, v17, v17
    v_cvt_pk_bf16_f32 v18, v18, v18
    v_cvt_pk_bf16_f32 v19, v19, v19
    v_and_b32 v16, 0xffff0000, v16
    v_and_b32 v17, 0xffff0000, v17
    v_and_b32 v18, 0xffff0000, v18
    v_and_b32 v19, 0xffff0000, v19
    v_mul_f32 v16, v16, v20
    v_mul_f32 v17, v17, v21
    v_mul_f32 v18, v18, v22
    v_mul_f32 v19, v19, v23
    v_cvt_pk_bf16_f32 v16, v16, v17
    v_cvt_pk_bf16_f32 v18, v18, v19
    v_cmp_eq_u32 vcc, 7, v12
    v_mov_b32 v17, s84
    v_mov_b32 v19, s84
    v_cndmask_b32 v16, v16, v4, vcc
    v_cndmask_b32 v18, v18, v4, vcc
    v_and_b32 v13, 3, v0
    v_lshlrev_b32 v13, 5, v13
    v_lshrrev_b32 v11, 2, v12
    v_lshl_add_u32 v13, v11, 4, v13
    s_mov_b32 exec_lo, 0xff
    s_mov_b32 exec_hi, 0x0
    buffer_store_dwordx4 v[16:19], v13, s[28:31], s46 offen sc1 nt
L_p_noh:
    s_mov_b32 exec_lo, 0xffffffff
    s_mov_b32 exec_hi, 0x0
Lsp_73:
    ds_read_b32 v3, v2 offset:0
    s_waitcnt lgkmcnt(0)
    v_readfirstlane_b32 s61, v3
    s_cmp_ge_i32 s61, 10
    s_cbranch_scc1 Lsp_74
    s_sub_u32 s60, s60, 1
    s_cbranch_scc0 Lsp_73
    s_mov_b32 s60, 0
Lsp_74:
    buffer_load_dword v37, v36, s[28:31], s54 offen sc1
    s_add_u32 s56, s48, 10
    v_mov_b32 v38, s56
    s_mov_b64 exec, 1
    buffer_store_dword v38, v4, s[28:31], s55 offen
    s_mov_b32 exec_lo, -1
    s_waitcnt vmcnt(1)
    v_subrev_u32 v37, s56, v37
    v_cmp_gt_u32 vcc, 32, v37
    s_bcnt1_i32_b32 s61, vcc_lo
    s_cmp_lt_u32 s61, 12
    s_cselect_b32 s56, 1, 0
    s_cmp_ge_u32 s61, 26
    s_cselect_b32 s56, 2, s56
    v_mov_b32 v37, s56
    ds_write_b32 v2, v37 offset:2088
    s_mov_b64 exec, -1
    s_mov_b32 exec_lo, 0xffffffff
    s_mov_b32 exec_hi, 0x0
Lsp_75:
    ds_read_b32 v3, v2 offset:0
    s_waitcnt lgkmcnt(0)
    v_readfirstlane_b32 s61, v3
    s_cmp_ge_i32 s61, 12
    s_cbranch_scc1 Lsp_76
    s_sub_u32 s60, s60, 1
    s_cbranch_scc0 Lsp_75
    s_mov_b32 s60, 0
Lsp_76:
    buffer_load_dword v37, v36, s[28:31], s54 offen sc1
    s_add_u32 s56, s48, 12
    v_mov_b32 v38, s56
    s_mov_b64 exec, 1
    buffer_store_dword v38, v4, s[28:31], s55 offen
    s_mov_b32 exec_lo, -1
    s_waitcnt vmcnt(1)
    v_subrev_u32 v37, s56, v37
    v_cmp_gt_u32 vcc, 32, v37
    s_bcnt1_i32_b32 s61, vcc_lo
    s_cmp_lt_u32 s61, 12
    s_cselect_b32 s56, 1, 0
    s_cmp_ge_u32 s61, 26
    s_cselect_b32 s56, 2, s56
    v_mov_b32 v37, s56
    ds_write_b32 v2, v37 offset:2088
    s_mov_b64 exec, -1
    s_mov_b32 exec_lo, 0xffffffff
    s_mov_b32 exec_hi, 0x0
    v_add_u32 v13, 137472, v15
Lsp_77:
    ds_read_b32 v3, v2 offset:0
    s_waitcnt lgkmcnt(0)
    v_readfirstlane_b32 s61, v3
    s_cmp_ge_i32 s61, 13
    s_cbranch_scc1 Lsp_78
    s_sub_u32 s60, s60, 1
    s_cbranch_scc0 Lsp_77
    s_mov_b32 s60, 0
Lsp_78:
Lpl_79:
    buffer_load_dwordx4 v[16:19], v1, s[28:31], s45 offen sc1
Lpl_81:
    s_waitcnt vmcnt(0)
    v_xor_b32 v17, s84, v17
    v_xor_b32 v19, s84, v19
    v_or_b32 v20, v17, v19
    v_cmp_ne_u32 vcc, 0, v20
    s_cbranch_vccz Lpl_80
    s_mov_b64 exec, vcc
    s_sleep 16
    s_sub_u32 s60, s60, 16
    s_cbranch_scc0 Lpl_79
    s_mov_b32 s60, 0
Lpl_80:
    s_mov_b64 exec, -1
    s_mov_b32 exec_lo, 0xffffffff
    s_mov_b32 exec_hi, 0x0
    v_mov_b32 v17, v18
    ds_write_b64 v13, v[16:17]
    ds_write_b32 v2, v10 offset:2064
    s_mov_b64 exec, -1
    s_lshl_b32 s47, s64, 13
    s_and_b32 s73, s2, 7
    s_lshl_b32 s73, s73, 4
    s_add_u32 s47, s47, s73
    v_lshlrev_b32 v11, 7, v0
    s_add_u32 s47, s47, 393216
    s_mov_b32 s50, 0x3fb8aa3b
    v_lshl_add_u32 v13, v12, 3, v14
    v_lshlrev_b32 v13, 2, v13
    v_add_u32 v13, 137984, v13
    s_add_u32 s46, s51, 655360
    s_add_u32 s45, s51, 524288
    v_lshlrev_b32 v6, 12, v0
    v_add_u32 v7, 139264, v1
    s_lshl_b32 s52, s66, 3
    s_add_u32 s52, s52, s67
    s_lshl_b32 s52, s52, 9
    s_add_u32 s53, s52, 655360
    s_add_u32 s52, s52, 524288
    v_lshlrev_b32 v9, 16, v9
    s_mov_b32 exec_lo, 0xffffffff
    s_mov_b32 exec_hi, 0x0
Lsp_82:
    ds_read_b32 v3, v2 offset:0
    s_waitcnt lgkmcnt(0)
    v_readfirstlane_b32 s61, v3
    s_cmp_ge_i32 s61, 14
    s_cbranch_scc1 Lsp_83
    s_sub_u32 s60, s60, 1
    s_cbranch_scc0 Lsp_82
    s_mov_b32 s60, 0
Lsp_83:
    buffer_load_dword v37, v36, s[28:31], s54 offen sc1
    s_add_u32 s56, s48, 14
    v_mov_b32 v38, s56
    s_mov_b64 exec, 1
    buffer_store_dword v38, v4, s[28:31], s55 offen
    s_mov_b32 exec_lo, -1
    s_waitcnt vmcnt(1)
    v_subrev_u32 v37, s56, v37
    v_cmp_gt_u32 vcc, 32, v37
    s_bcnt1_i32_b32 s61, vcc_lo
    s_cmp_lt_u32 s61, 12
    s_cselect_b32 s56, 1, 0
    s_cmp_ge_u32 s61, 26
    s_cselect_b32 s56, 2, s56
    v_mov_b32 v37, s56
    ds_write_b32 v2, v37 offset:2088
    s_mov_b64 exec, -1
    s_mov_b32 exec_lo, 0xffffffff
    s_mov_b32 exec_hi, 0x0
Lsp_84:
    ds_read_b32 v3, v2 offset:0
    s_waitcnt lgkmcnt(0)
    v_readfirstlane_b32 s61, v3
    s_cmp_ge_i32 s61, 16
    s_cbranch_scc1 Lsp_85
    s_sub_u32 s60, s60, 1
    s_cbranch_scc0 Lsp_84
    s_mov_b32 s60, 0
Lsp_85:
    buffer_load_dword v37, v36, s[28:31], s54 offen sc1
    s_add_u32 s56, s48, 16
    v_mov_b32 v38, s56
    s_mov_b64 exec, 1
    buffer_store_dword v38, v4, s[28:31], s55 offen
    s_mov_b32 exec_lo, -1
    s_waitcnt vmcnt(1)
    v_subrev_u32 v37, s56, v37
    v_cmp_gt_u32 vcc, 32, v37
    s_bcnt1_i32_b32 s61, vcc_lo
    s_cmp_lt_u32 s61, 24
    s_cselect_b32 s56, 1, 0
    v_mov_b32 v37, s56
    ds_write_b32 v2, v37 offset:2072
    s_mov_b64 exec, -1
Lsp_86:
    ds_read_b32 v3, v2 offset:0
    s_waitcnt lgkmcnt(0)
    v_readfirstlane_b32 s61, v3
    s_cmp_ge_i32 s61, 17
    s_cbranch_scc1 Lsp_87
    s_sub_u32 s60, s60, 1
    s_cbranch_scc0 Lsp_86
    s_mov_b32 s60, 0
Lsp_87:
Lpl_88:
    buffer_load_dwordx4 v[16:19], v11, s[28:31], s47 offen sc1
Lpl_90:
    s_waitcnt vmcnt(0)
    v_xor_b32 v16, s80, v16
    v_xor_b32 v17, s81, v17
    v_xor_b32 v18, s82, v18
    v_xor_b32 v19, s83, v19
    v_or3_b32 v20, v16, v17, v18
    v_or_b32 v20, v20, v19
    v_and_b32 v20, 0x3ff, v20
    v_cmp_ne_u32 vcc, 0, v20
    s_cbranch_vccz Lpl_89
    s_mov_b64 exec, vcc
    s_sleep 12
    s_sub_u32 s60, s60, 16
    s_cbranch_scc0 Lpl_88
    s_mov_b32 s60, 0
Lpl_89:
    s_mov_b64 exec, -1
    v_mov_b32 v18, v16
    s_nop 1
    v_max_f32_dpp v18, v18, v18 quad_perm:[1,0,3,2] row_mask:0xf bank_mask:0xf
    s_nop 1
    v_max_f32_dpp v18, v18, v18 quad_perm:[2,3,0,1] row_mask:0xf bank_mask:0xf
    s_nop 1
    v_max_f32_dpp v18, v18, v18 row_half_mirror row_mask:0xf bank_mask:0xf
    s_nop 1
    v_max_f32_dpp v18, v18, v18 row_mirror row_mask:0xf bank_mask:0xf
    v_mov_b32 v19, v18
    s_nop 1
    v_permlane16_swap_b32 v18, v19
    v_max_f32 v18, v18, v19
    v_mov_b32 v19, v18
    s_nop 1
    v_permlane32_swap_b32 v18, v19
    v_max_f32 v18, v18, v19
    v_sub_f32 v16, v16, v18
    v_mul_f32 v16, s50, v16
    v_exp_f32 v16, v16
    s_nop 0
    v_mul_f32 v17, v17, v16
    s_nop 1
    v_add_f32_dpp v17, v17, v17 quad_perm:[1,0,3,2] row_mask:0xf bank_mask:0xf
    s_nop 1
    v_add_f32_dpp v17, v17, v17 quad_perm:[2,3,0,1] row_mask:0xf bank_mask:0xf
    s_nop 1
    v_add_f32_dpp v17, v17, v17 row_half_mirror row_mask:0xf bank_mask:0xf
    s_nop 1
    v_add_f32_dpp v17, v17, v17 row_mirror row_mask:0xf bank_mask:0xf
    v_mov_b32 v19, v17
    s_nop 1
    v_permlane16_swap_b32 v17, v19
    v_add_f32 v17, v17, v19
    v_mov_b32 v19, v17
    s_nop 1
    v_permlane32_swap_b32 v17, v19
    v_add_f32 v17, v17, v19
    v_rcp_f32 v18, v17
    s_nop 0
    v_fma_f32 v19, -v17, v18, 1.0
    v_fmac_f32 v18, v19, v18
    v_mul_f32 v16, v16, v18
    ds_write_b32 v13, v16
    s_mov_b64 exec, 1
    ds_write_b32 v2, v10 offset:2068
    s_mov_b64 exec, -1
    s_mov_b32 exec_lo, 0xffffffff
    s_mov_b32 exec_hi, 0x0
Lsp_91:
    ds_read_b32 v3, v2 offset:2080
    s_waitcnt lgkmcnt(0)
    v_readfirstlane_b32 s61, v3
    s_cmp_ge_i32 s61, 1
    s_cbranch_scc1 Lsp_92
    s_sub_u32 s60, s60, 1
    s_cbranch_scc0 Lsp_91
    s_mov_b32 s60, 0
Lsp_92:
Lsp_93:
    ds_read_b32 v3, v2 offset:2080
    ds_read_b128 v[16:19], v7 offset:0
    ds_read_b128 v[20:23], v7 offset:512
    ds_read_b128 v[24:27], v7 offset:1024
    ds_read_b128 v[28:31], v7 offset:1536
    s_waitcnt lgkmcnt(0)
    v_readfirstlane_b32 s61, v3
    s_cmp_ge_i32 s61, 4
    s_cbranch_scc1 Lsp_94
    s_sub_u32 s60, s60, 1
    s_cbranch_scc0 Lsp_93
    s_mov_b32 s60, 0
Lsp_94:
    v_pk_add_f32 v[16:17], v[16:17], v[20:21]
    v_pk_add_f32 v[24:25], v[24:25], v[28:29]
    v_pk_add_f32 v[18:19], v[18:19], v[22:23]
    v_pk_add_f32 v[26:27], v[26:27], v[30:31]
    v_pk_add_f32 v[16:17], v[16:17], v[24:25]
    v_pk_add_f32 v[18:19], v[18:19], v[26:27]
    v_bfi_b32 v16, v5, s80, v16
    v_bfi_b32 v17, v5, s81, v17
    v_bfi_b32 v18, v5, s82, v18
    v_bfi_b32 v19, v5, s83, v19
    buffer_store_dwordx4 v[16:19], v1, s[28:31], s52 offen sc1
    s_mov_b32 exec_lo, 0xffffffff
    s_mov_b32 exec_hi, 0x0
Lsp_95:
    ds_read_b32 v3, v2 offset:2084
    s_waitcnt lgkmcnt(0)
    v_readfirstlane_b32 s61, v3
    s_cmp_ge_i32 s61, 1
    s_cbranch_scc1 Lsp_96
    s_sub_u32 s60, s60, 1
    s_cbranch_scc0 Lsp_95
    s_mov_b32 s60, 0
Lsp_96:
Lsp_97:
    ds_read_b32 v3, v2 offset:2084
    ds_read_b128 v[16:19], v7 offset:2048
    ds_read_b128 v[20:23], v7 offset:2560
    ds_read_b128 v[24:27], v7 offset:3072
    ds_read_b128 v[28:31], v7 offset:3584
    s_waitcnt lgkmcnt(0)
    v_readfirstlane_b32 s61, v3
    s_cmp_ge_i32 s61, 4
    s_cbranch_scc1 Lsp_98
    s_sub_u32 s60, s60, 1
    s_cbranch_scc0 Lsp_97
    s_mov_b32 s60, 0
Lsp_98:
    v_pk_add_f32 v[16:17], v[16:17], v[20:21]
    v_pk_add_f32 v[24:25], v[24:25], v[28:29]
    v_pk_add_f32 v[18:19], v[18:19], v[22:23]
    v_pk_add_f32 v[26:27], v[26:27], v[30:31]
    v_pk_add_f32 v[16:17], v[16:17], v[24:25]
    v_pk_add_f32 v[18:19], v[18:19], v[26:27]
    v_bfi_b32 v16, v5, s80, v16
    v_bfi_b32 v17, v5, s81, v17
    v_bfi_b32 v18, v5, s82, v18
    v_bfi_b32 v19, v5, s83, v19
    buffer_store_dwordx4 v[16:19], v1, s[28:31], s53 offen sc1
    s_mov_b64 exec, -1
    v_mov_b32 v32, 0
    v_mov_b32 v33, 0
    v_mov_b32 v34, 0
    v_mov_b32 v35, 0
    s_mov_b32 exec_hi, 0
Lpl_99:
    buffer_load_dwordx4 v[32:35], v6, s[28:31], s45 offen sc1
Lpl_101:
    s_waitcnt vmcnt(0)
    v_xor_b32 v32, s80, v32
    v_xor_b32 v33, s81, v33
    v_xor_b32 v34, s82, v34
    v_xor_b32 v35, s83, v35
    v_or3_b32 v24, v32, v33, v34
    v_or_b32 v24, v24, v35
    v_and_b32 v24, 0x3ff, v24
    v_cmp_ne_u32 vcc, 0, v24
    s_cbranch_vccz Lpl_100
    s_mov_b64 exec, vcc
    s_sub_u32 s60, s60, 16
    s_cbranch_scc0 Lpl_99
    s_mov_b32 s60, 0
Lpl_100:
    s_mov_b64 exec, -1
    v_permlane32_swap_b32 v32, v33
    v_permlane32_swap_b32 v34, v35
    v_add_f32 v32, v32, v33
    v_add_f32 v34, v34, v35
    s_nop 1
    v_permlane16_swap_b32 v32, v34
    v_add_f32 v32, v32, v34
    s_nop 1
    v_add_f32_dpp v32, v32, v32 row_ror:8 row_mask:0xf bank_mask:0xf
    s_nop 1
    v_add_f32_dpp v32, v32, v32 row_ror:4 row_mask:0xf bank_mask:0xf
    s_nop 1
    v_add_f32_dpp v32, v32, v32 row_ror:2 row_mask:0xf bank_mask:0xf
    s_nop 1
    v_add_f32_dpp v32, v32, v32 row_ror:1 row_mask:0xf bank_mask:0xf
    v_cvt_pk_bf16_f32 v32, v32, v32
    v_and_b32 v32, 0xffff0000, v32
    v_mul_f32 v24, 0xbfb8aa3b, v32
    v_exp_f32 v24, v24
    s_nop 0
    v_add_f32 v24, 1.0, v24
    v_rcp_f32 v24, v24
    s_nop 0
    v_mul_f32 v32, v32, v24
    v_cvt_pk_bf16_f32 v32, v32, v32
    v_and_b32 v32, 0xffff0000, v32
    v_mov_b32 v14, v32
    s_mov_b64 exec, -1
    v_mov_b32 v32, 0
    v_mov_b32 v33, 0
    v_mov_b32 v34, 0
    v_mov_b32 v35, 0
    s_mov_b32 exec_hi, 0
Lpl_102:
    buffer_load_dwordx4 v[32:35], v6, s[28:31], s46 offen sc1
Lpl_104:
    s_waitcnt vmcnt(0)
    v_xor_b32 v32, s80, v32
    v_xor_b32 v33, s81, v33
    v_xor_b32 v34, s82, v34
    v_xor_b32 v35, s83, v35
    v_or3_b32 v24, v32, v33, v34
    v_or_b32 v24, v24, v35
    v_and_b32 v24, 0x3ff, v24
    v_cmp_ne_u32 vcc, 0, v24
    s_cbranch_vccz Lpl_103
    s_mov_b64 exec, vcc
    s_sub_u32 s60, s60, 16
    s_cbranch_scc0 Lpl_102
    s_mov_b32 s60, 0
Lpl_103:
    s_mov_b64 exec, -1
    v_permlane32_swap_b32 v32, v33
    v_permlane32_swap_b32 v34, v35
    v_add_f32 v32, v32, v33
    v_add_f32 v34, v34, v35
    s_nop 1
    v_permlane16_swap_b32 v32, v34
    v_add_f32 v32, v32, v34
    s_nop 1
    v_add_f32_dpp v32, v32, v32 row_ror:8 row_mask:0xf bank_mask:0xf
    s_nop 1
    v_add_f32_dpp v32, v32, v32 row_ror:4 row_mask:0xf bank_mask:0xf
    s_nop 1
    v_add_f32_dpp v32, v32, v32 row_ror:2 row_mask:0xf bank_mask:0xf
    s_nop 1
    v_add_f32_dpp v32, v32, v32 row_ror:1 row_mask:0xf bank_mask:0xf
    v_cvt_pk_bf16_f32 v32, v32, v32
    v_and_b32 v32, 0xffff0000, v32
    v_mul_f32 v32, v32, v14
    v_cvt_pk_bf16_f32 v32, v32, v32
    v_and_b32 v32, 0xffff0000, v32
    v_add_f32 v32, v32, v9
    v_cvt_pk_bf16_f32 v32, v32, v32
    s_mov_b32 exec_lo, 0x10001
    s_mov_b32 exec_hi, 0x10001
    buffer_store_short v32, v8, s[40:43], s44 offen
    s_cmp_lg_u32 s2, 0
    s_cbranch_scc1 Lnoep_105
    s_mov_b64 exec, 1
    v_mov_b32 v16, s84
    s_mov_b32 s45, 425984
    buffer_store_dword v16, v4, s[28:31], s45 offen
Lnoep_105:
L_end:
    s_endpgm
.section .rodata,"a"
.p2align 6
.amdhsa_kernel recurrent_scan__gqa_block_cached__swiglu_ffn__decode_kernel
  .amdhsa_next_free_vgpr 168
  .amdhsa_next_free_sgpr 96
  .amdhsa_accum_offset 168
  .amdhsa_group_segment_fixed_size 0
  .amdhsa_kernarg_size 96
  .amdhsa_user_sgpr_count 2
  .amdhsa_user_sgpr_kernarg_segment_ptr 1
  .amdhsa_system_sgpr_workgroup_id_x 1
  .amdhsa_float_denorm_mode_32 3
.end_amdhsa_kernel
```
